```python
import torch

def _softmax(x, axis=-1):
    return torch.softmax(x, dim=axis)
def _gelu(x):
    return torch.nn.functional.gelu(x, approximate="tanh")
def _silu(x):
    return torch.nn.functional.silu(x)
def _sigmoid(x):
    return torch.sigmoid(x)
def _layernorm(x, axis=-1, eps=1e-5):
    m = x.mean(dim=axis, keepdim=True)
    v = x.var(dim=axis, keepdim=True, unbiased=False)
    return (x - m) / torch.sqrt(v + eps)
def _scatter_add(tgt, idx, src, axis=0):
    return tgt.clone().index_add_(axis, idx, src)
def _segment_sum(src, seg, n):
    out = torch.zeros((n,) + src.shape[1:], dtype=src.dtype)
    return out.index_add_(0, seg, src)
def _pad(x, pw):
    flat = tuple(v for pair in reversed(pw) for v in pair)
    return torch.nn.functional.pad(x, flat)

kernel_name = 'concat_heads__sliding_block__softmax_full_mha__prompt'

def setup_inputs():

    _w = (lambda a: (lambda t: t.to(torch.bfloat16) if t.is_floating_point() else t)(torch.as_tensor(a)))
    def _A_setup():
        B, S, D = 1, 2048, 512
        return {
            "x": _w((lambda *s: torch.randn(*s, dtype=torch.bfloat16) * 0.4)(B, S, D)),
            "wqkv": _w((lambda *s: torch.randn(*s, dtype=torch.bfloat16) * 0.4)(D, 3 * D)),
            "wo": _w((lambda *s: torch.randn(*s, dtype=torch.bfloat16) * 0.05)(D, D)),
        }
    _A_in = _A_setup()

    def _B_setup():
        B, S, D = 1, 2048, 512
        return {
            "x": _w((lambda *s: torch.randn(*s, dtype=torch.bfloat16) * 0.2)(B, S, D)),
            "wqkv": _w((lambda *s: torch.randn(*s, dtype=torch.bfloat16) * 0.4)(D, 3 * D)),
            "wo": _w((lambda *s: torch.randn(*s, dtype=torch.bfloat16) * 0.1)(D, D)),
        }
    _B_in = _B_setup()

    return {
        "A_x": _A_in["x"],
        "A_wqkv": _A_in["wqkv"],
        "A_wo": _A_in["wo"],
        "B_x": _B_in["x"],
        "B_wqkv": _B_in["wqkv"],
        "B_wo": _B_in["wo"],
    }

def reference(A_x, A_wqkv, A_wo, B_x, B_wqkv, B_wo):
    def _A_ref(x, wqkv, wo):
        B, S, D = x.shape
        H = 32; Dh = D // H; W = 256
        qkv = (lambda x, *d: x.permute(*d))((x @ wqkv).reshape(B, S, 3, H, Dh), 2, 0, 3, 1, 4)
        q, k, v = qkv[0], qkv[1], qkv[2]
        scores = torch.einsum("bhqd,bhkd->bhqk", q, k) * (Dh ** -0.5)
        idx = torch.arange(S)
        mask = (idx[:, None] - idx[None, :] >= 0) & (idx[:, None] - idx[None, :] < W)
        scores = torch.where(mask[None, None], scores, -1e9)
        p = _softmax(scores, axis=-1)
        o = torch.einsum("bhqk,bhkd->bhqd", p, v)
        return (lambda x, *d: x.permute(*d))(o, 0, 2, 1, 3).reshape(B, S, D) @ wo

    def _B_ref(x, wqkv, wo):
        B, S, D = x.shape
        H = 32; Dh = D // H
        qkv = (lambda x, *d: x.permute(*d))((x @ wqkv).reshape(B, S, 3, H, Dh), 2, 0, 3, 1, 4)
        q, k, v = qkv[0], qkv[1], qkv[2]
        scale = Dh ** -0.5
        scores = torch.einsum("bhqd,bhkd->bhqk", q, k) * scale
        p = _softmax(scores, axis=-1)
        o = torch.einsum("bhqk,bhkd->bhqd", p, v)
        return (lambda x, *d: x.permute(*d))(o, 0, 2, 1, 3).reshape(B, S, D) @ wo

    a = _A_ref(A_x, A_wqkv, A_wo)
    b = _B_ref(B_x, B_wqkv, B_wo)
    return torch.concatenate([a, b], axis=-1)
```

```asm
; @launch kernel=qkv_kernel grid=(256,1,1) block=(256,1,1) lds=86016
; @launch kernel=attn_kernel grid=(1024,1,1) block=(256,1,1) lds=24576
; @launch kernel=oproj_kernel grid=(256,1,1) block=(256,1,1) lds=36864
.amdgcn_target "amdgcn-amd-amdhsa--gfx950"
.text
.globl qkv_kernel
.p2align 8
.type qkv_kernel,@function
qkv_kernel:
    s_cmp_ge_u32 s2, 256
    s_cbranch_scc1 L_k1_end
    s_lshr_b32 s24, s2, 7
    s_mul_i32 s25, s24, 24
    s_add_u32 s26, s0, s25
    s_addc_u32 s27, s1, 0
    s_load_dwordx4 s[4:7], s[26:27], 0
    s_load_dwordx2 s[8:9], s[0:1], 64
    s_and_b32 s28, s2, 127
    s_lshr_b32 s29, s28, 3
    s_and_b32 s30, s28, 7
    v_and_b32 v1, 63, v0
    v_lshrrev_b32 v2, 6, v0
    s_nop 0
    v_readfirstlane_b32 s31, v2
    s_waitcnt lgkmcnt(0)
    s_mov_b32 s12, s4
    s_and_b32 s13, s5, 0xffff
    s_mov_b32 s14, 2097152
    s_mov_b32 s15, 0x00020000
    s_mov_b32 s16, s6
    s_and_b32 s17, s7, 0xffff
    s_mov_b32 s18, 1572864
    s_mov_b32 s19, 0x00020000
    s_mov_b32 s20, s8
    s_and_b32 s21, s9, 0xffff
    s_mov_b32 s22, 12582912
    s_mov_b32 s23, 0x00020000
    s_lshl_b32 s32, s29, 7
    s_lshl_b32 s33, s31, 5
    s_add_u32 s32, s32, s33
    v_and_b32 v4, 31, v1
    v_add_u32 v3, s32, v4
    v_lshlrev_b32 v3, 10, v3
    v_lshrrev_b32 v5, 5, v1
    v_lshlrev_b32 v6, 6, v5
    v_add_u32 v3, v3, v6
    v_lshrrev_b32 v14, 2, v0
    v_and_b32 v15, 3, v0
    v_mul_u32_u24 v15, 6, v15
    s_movk_i32 s34, 3072
    v_mul_lo_u32 v16, v14, s34
    s_lshl_b32 s35, s30, 8
    v_add_u32 v16, s35, v16
    s_lshl_b32 s36, s30, 7
    s_sub_u32 s36, 1792, s36
    v_mov_b32 v17, s36
    v_add_u32 v18, 0, v15
    v_lshl_add_u32 v8, v18, 4, v16
    v_cmp_le_u32 vcc, 16, v18
    s_nop 1
    v_cndmask_b32 v19, 0, v17, vcc
    v_add_u32 v8, v8, v19
    v_add_u32 v18, 1, v15
    v_lshl_add_u32 v9, v18, 4, v16
    v_cmp_le_u32 vcc, 16, v18
    s_nop 1
    v_cndmask_b32 v19, 0, v17, vcc
    v_add_u32 v9, v9, v19
    v_add_u32 v18, 2, v15
    v_lshl_add_u32 v10, v18, 4, v16
    v_cmp_le_u32 vcc, 16, v18
    s_nop 1
    v_cndmask_b32 v19, 0, v17, vcc
    v_add_u32 v10, v10, v19
    v_add_u32 v18, 3, v15
    v_lshl_add_u32 v11, v18, 4, v16
    v_cmp_le_u32 vcc, 16, v18
    s_nop 1
    v_cndmask_b32 v19, 0, v17, vcc
    v_add_u32 v11, v11, v19
    v_add_u32 v18, 4, v15
    v_lshl_add_u32 v12, v18, 4, v16
    v_cmp_le_u32 vcc, 16, v18
    s_nop 1
    v_cndmask_b32 v19, 0, v17, vcc
    v_add_u32 v12, v12, v19
    v_add_u32 v18, 5, v15
    v_lshl_add_u32 v13, v18, 4, v16
    v_cmp_le_u32 vcc, 16, v18
    s_nop 1
    v_cndmask_b32 v19, 0, v17, vcc
    v_add_u32 v13, v13, v19
    s_movk_i32 s37, 448
    v_mul_lo_u32 v7, v14, s37
    v_lshl_add_u32 v7, v15, 4, v7
    v_lshrrev_b32 v16, 2, v1
    v_and_b32 v16, 3, v16
    v_lshl_add_u32 v16, v5, 5, v16
    v_mul_lo_u32 v20, v16, s37
    v_lshrrev_b32 v17, 4, v1
    v_and_b32 v17, 1, v17
    v_lshlrev_b32 v17, 5, v17
    v_and_b32 v18, 3, v1
    v_lshl_add_u32 v17, v18, 3, v17
    v_add_u32 v20, v20, v17
    v_add_u32 v6, 57344, v20
    v_add_u32 v19, 57344, v7
    v_accvgpr_write_b32 a0, 0
    v_accvgpr_write_b32 a1, 0
    v_accvgpr_write_b32 a2, 0
    v_accvgpr_write_b32 a3, 0
    v_accvgpr_write_b32 a4, 0
    v_accvgpr_write_b32 a5, 0
    v_accvgpr_write_b32 a6, 0
    v_accvgpr_write_b32 a7, 0
    v_accvgpr_write_b32 a8, 0
    v_accvgpr_write_b32 a9, 0
    v_accvgpr_write_b32 a10, 0
    v_accvgpr_write_b32 a11, 0
    v_accvgpr_write_b32 a12, 0
    v_accvgpr_write_b32 a13, 0
    v_accvgpr_write_b32 a14, 0
    v_accvgpr_write_b32 a15, 0
    v_accvgpr_write_b32 a16, 0
    v_accvgpr_write_b32 a17, 0
    v_accvgpr_write_b32 a18, 0
    v_accvgpr_write_b32 a19, 0
    v_accvgpr_write_b32 a20, 0
    v_accvgpr_write_b32 a21, 0
    v_accvgpr_write_b32 a22, 0
    v_accvgpr_write_b32 a23, 0
    v_accvgpr_write_b32 a24, 0
    v_accvgpr_write_b32 a25, 0
    v_accvgpr_write_b32 a26, 0
    v_accvgpr_write_b32 a27, 0
    v_accvgpr_write_b32 a28, 0
    v_accvgpr_write_b32 a29, 0
    v_accvgpr_write_b32 a30, 0
    v_accvgpr_write_b32 a31, 0
    v_accvgpr_write_b32 a32, 0
    v_accvgpr_write_b32 a33, 0
    v_accvgpr_write_b32 a34, 0
    v_accvgpr_write_b32 a35, 0
    v_accvgpr_write_b32 a36, 0
    v_accvgpr_write_b32 a37, 0
    v_accvgpr_write_b32 a38, 0
    v_accvgpr_write_b32 a39, 0
    v_accvgpr_write_b32 a40, 0
    v_accvgpr_write_b32 a41, 0
    v_accvgpr_write_b32 a42, 0
    v_accvgpr_write_b32 a43, 0
    v_accvgpr_write_b32 a44, 0
    v_accvgpr_write_b32 a45, 0
    v_accvgpr_write_b32 a46, 0
    v_accvgpr_write_b32 a47, 0
    v_accvgpr_write_b32 a48, 0
    v_accvgpr_write_b32 a49, 0
    v_accvgpr_write_b32 a50, 0
    v_accvgpr_write_b32 a51, 0
    v_accvgpr_write_b32 a52, 0
    v_accvgpr_write_b32 a53, 0
    v_accvgpr_write_b32 a54, 0
    v_accvgpr_write_b32 a55, 0
    v_accvgpr_write_b32 a56, 0
    v_accvgpr_write_b32 a57, 0
    v_accvgpr_write_b32 a58, 0
    v_accvgpr_write_b32 a59, 0
    v_accvgpr_write_b32 a60, 0
    v_accvgpr_write_b32 a61, 0
    v_accvgpr_write_b32 a62, 0
    v_accvgpr_write_b32 a63, 0
    v_accvgpr_write_b32 a64, 0
    v_accvgpr_write_b32 a65, 0
    v_accvgpr_write_b32 a66, 0
    v_accvgpr_write_b32 a67, 0
    v_accvgpr_write_b32 a68, 0
    v_accvgpr_write_b32 a69, 0
    v_accvgpr_write_b32 a70, 0
    v_accvgpr_write_b32 a71, 0
    v_accvgpr_write_b32 a72, 0
    v_accvgpr_write_b32 a73, 0
    v_accvgpr_write_b32 a74, 0
    v_accvgpr_write_b32 a75, 0
    v_accvgpr_write_b32 a76, 0
    v_accvgpr_write_b32 a77, 0
    v_accvgpr_write_b32 a78, 0
    v_accvgpr_write_b32 a79, 0
    v_accvgpr_write_b32 a80, 0
    v_accvgpr_write_b32 a81, 0
    v_accvgpr_write_b32 a82, 0
    v_accvgpr_write_b32 a83, 0
    v_accvgpr_write_b32 a84, 0
    v_accvgpr_write_b32 a85, 0
    v_accvgpr_write_b32 a86, 0
    v_accvgpr_write_b32 a87, 0
    v_accvgpr_write_b32 a88, 0
    v_accvgpr_write_b32 a89, 0
    v_accvgpr_write_b32 a90, 0
    v_accvgpr_write_b32 a91, 0
    v_accvgpr_write_b32 a92, 0
    v_accvgpr_write_b32 a93, 0
    v_accvgpr_write_b32 a94, 0
    v_accvgpr_write_b32 a95, 0
    s_mov_b32 s40, 0
    s_mov_b32 s41, 0
    buffer_load_dwordx4 v[96:99], v8, s[16:19], s41 offen
    buffer_load_dwordx4 v[100:103], v9, s[16:19], s41 offen
    buffer_load_dwordx4 v[104:107], v10, s[16:19], s41 offen
    buffer_load_dwordx4 v[108:111], v11, s[16:19], s41 offen
    buffer_load_dwordx4 v[112:115], v12, s[16:19], s41 offen
    buffer_load_dwordx4 v[116:119], v13, s[16:19], s41 offen
    buffer_load_dwordx4 v[64:67], v3, s[12:15], s40 offen offset:0
    buffer_load_dwordx4 v[68:71], v3, s[12:15], s40 offen offset:16
    buffer_load_dwordx4 v[72:75], v3, s[12:15], s40 offen offset:32
    buffer_load_dwordx4 v[76:79], v3, s[12:15], s40 offen offset:48
    s_mov_b32 s40, 128
    s_mov_b32 s41, 196608
    buffer_load_dwordx4 v[144:147], v8, s[16:19], s41 offen
    buffer_load_dwordx4 v[148:151], v9, s[16:19], s41 offen
    buffer_load_dwordx4 v[152:155], v10, s[16:19], s41 offen
    buffer_load_dwordx4 v[156:159], v11, s[16:19], s41 offen
    buffer_load_dwordx4 v[160:163], v12, s[16:19], s41 offen
    buffer_load_dwordx4 v[164:167], v13, s[16:19], s41 offen
    buffer_load_dwordx4 v[80:83], v3, s[12:15], s40 offen offset:0
    buffer_load_dwordx4 v[84:87], v3, s[12:15], s40 offen offset:16
    buffer_load_dwordx4 v[88:91], v3, s[12:15], s40 offen offset:32
    buffer_load_dwordx4 v[92:95], v3, s[12:15], s40 offen offset:48
    s_waitcnt vmcnt(10)
    ds_write_b128 v7, v[96:99] offset:0
    ds_write_b128 v7, v[100:103] offset:16
    ds_write_b128 v7, v[104:107] offset:32
    ds_write_b128 v7, v[108:111] offset:48
    ds_write_b128 v7, v[112:115] offset:64
    ds_write_b128 v7, v[116:119] offset:80
    s_waitcnt lgkmcnt(0)
    s_barrier
    s_mov_b32 s40, 256
    s_mov_b32 s41, 393216
    buffer_load_dwordx4 v[96:99], v8, s[16:19], s41 offen
    buffer_load_dwordx4 v[100:103], v9, s[16:19], s41 offen
    buffer_load_dwordx4 v[104:107], v10, s[16:19], s41 offen
    buffer_load_dwordx4 v[108:111], v11, s[16:19], s41 offen
    buffer_load_dwordx4 v[112:115], v12, s[16:19], s41 offen
    buffer_load_dwordx4 v[116:119], v13, s[16:19], s41 offen
    buffer_load_dwordx4 v[128:131], v3, s[12:15], s40 offen offset:0
    buffer_load_dwordx4 v[132:135], v3, s[12:15], s40 offen offset:16
    buffer_load_dwordx4 v[136:139], v3, s[12:15], s40 offen offset:32
    buffer_load_dwordx4 v[140:143], v3, s[12:15], s40 offen offset:48
    ds_read_b64_tr_b16 v[32:33], v20 offset:0
    ds_read_b64_tr_b16 v[34:35], v20 offset:1792
    ds_read_b64_tr_b16 v[36:37], v20 offset:64
    ds_read_b64_tr_b16 v[38:39], v20 offset:1856
    ds_read_b64_tr_b16 v[40:41], v20 offset:128
    ds_read_b64_tr_b16 v[42:43], v20 offset:1920
    ds_read_b64_tr_b16 v[44:45], v20 offset:192
    ds_read_b64_tr_b16 v[46:47], v20 offset:1984
    ds_read_b64_tr_b16 v[48:49], v20 offset:256
    ds_read_b64_tr_b16 v[50:51], v20 offset:2048
    ds_read_b64_tr_b16 v[52:53], v20 offset:320
    ds_read_b64_tr_b16 v[54:55], v20 offset:2112
    ds_read_b64_tr_b16 v[224:225], v20 offset:3584
    ds_read_b64_tr_b16 v[226:227], v20 offset:5376
    ds_read_b64_tr_b16 v[228:229], v20 offset:3648
    ds_read_b64_tr_b16 v[230:231], v20 offset:5440
    ds_read_b64_tr_b16 v[232:233], v20 offset:3712
    ds_read_b64_tr_b16 v[234:235], v20 offset:5504
    ds_read_b64_tr_b16 v[236:237], v20 offset:3776
    ds_read_b64_tr_b16 v[238:239], v20 offset:5568
    ds_read_b64_tr_b16 v[240:241], v20 offset:3840
    ds_read_b64_tr_b16 v[242:243], v20 offset:5632
    ds_read_b64_tr_b16 v[244:245], v20 offset:3904
    ds_read_b64_tr_b16 v[246:247], v20 offset:5696
    s_waitcnt lgkmcnt(12)
    v_mfma_f32_32x32x16_bf16 a[0:15], v[32:35], v[64:67], a[0:15]
    v_mfma_f32_32x32x16_bf16 a[16:31], v[36:39], v[64:67], a[16:31]
    v_mfma_f32_32x32x16_bf16 a[32:47], v[40:43], v[64:67], a[32:47]
    v_mfma_f32_32x32x16_bf16 a[48:63], v[44:47], v[64:67], a[48:63]
    v_mfma_f32_32x32x16_bf16 a[64:79], v[64:67], v[48:51], a[64:79]
    v_mfma_f32_32x32x16_bf16 a[80:95], v[64:67], v[52:55], a[80:95]
    ds_read_b64_tr_b16 v[32:33], v20 offset:7168
    ds_read_b64_tr_b16 v[34:35], v20 offset:8960
    ds_read_b64_tr_b16 v[36:37], v20 offset:7232
    ds_read_b64_tr_b16 v[38:39], v20 offset:9024
    ds_read_b64_tr_b16 v[40:41], v20 offset:7296
    ds_read_b64_tr_b16 v[42:43], v20 offset:9088
    ds_read_b64_tr_b16 v[44:45], v20 offset:7360
    ds_read_b64_tr_b16 v[46:47], v20 offset:9152
    ds_read_b64_tr_b16 v[48:49], v20 offset:7424
    ds_read_b64_tr_b16 v[50:51], v20 offset:9216
    ds_read_b64_tr_b16 v[52:53], v20 offset:7488
    ds_read_b64_tr_b16 v[54:55], v20 offset:9280
    s_waitcnt lgkmcnt(12)
    v_mfma_f32_32x32x16_bf16 a[0:15], v[224:227], v[68:71], a[0:15]
    v_mfma_f32_32x32x16_bf16 a[16:31], v[228:231], v[68:71], a[16:31]
    v_mfma_f32_32x32x16_bf16 a[32:47], v[232:235], v[68:71], a[32:47]
    v_mfma_f32_32x32x16_bf16 a[48:63], v[236:239], v[68:71], a[48:63]
    v_mfma_f32_32x32x16_bf16 a[64:79], v[68:71], v[240:243], a[64:79]
    v_mfma_f32_32x32x16_bf16 a[80:95], v[68:71], v[244:247], a[80:95]
    ds_read_b64_tr_b16 v[224:225], v20 offset:10752
    ds_read_b64_tr_b16 v[226:227], v20 offset:12544
    ds_read_b64_tr_b16 v[228:229], v20 offset:10816
    ds_read_b64_tr_b16 v[230:231], v20 offset:12608
    ds_read_b64_tr_b16 v[232:233], v20 offset:10880
    ds_read_b64_tr_b16 v[234:235], v20 offset:12672
    ds_read_b64_tr_b16 v[236:237], v20 offset:10944
    ds_read_b64_tr_b16 v[238:239], v20 offset:12736
    ds_read_b64_tr_b16 v[240:241], v20 offset:11008
    ds_read_b64_tr_b16 v[242:243], v20 offset:12800
    ds_read_b64_tr_b16 v[244:245], v20 offset:11072
    ds_read_b64_tr_b16 v[246:247], v20 offset:12864
    s_waitcnt lgkmcnt(12)
    v_mfma_f32_32x32x16_bf16 a[0:15], v[32:35], v[72:75], a[0:15]
    v_mfma_f32_32x32x16_bf16 a[16:31], v[36:39], v[72:75], a[16:31]
    v_mfma_f32_32x32x16_bf16 a[32:47], v[40:43], v[72:75], a[32:47]
    v_mfma_f32_32x32x16_bf16 a[48:63], v[44:47], v[72:75], a[48:63]
    v_mfma_f32_32x32x16_bf16 a[64:79], v[72:75], v[48:51], a[64:79]
    v_mfma_f32_32x32x16_bf16 a[80:95], v[72:75], v[52:55], a[80:95]
    s_waitcnt lgkmcnt(0)
    v_mfma_f32_32x32x16_bf16 a[0:15], v[224:227], v[76:79], a[0:15]
    v_mfma_f32_32x32x16_bf16 a[16:31], v[228:231], v[76:79], a[16:31]
    v_mfma_f32_32x32x16_bf16 a[32:47], v[232:235], v[76:79], a[32:47]
    v_mfma_f32_32x32x16_bf16 a[48:63], v[236:239], v[76:79], a[48:63]
    v_mfma_f32_32x32x16_bf16 a[64:79], v[76:79], v[240:243], a[64:79]
    v_mfma_f32_32x32x16_bf16 a[80:95], v[76:79], v[244:247], a[80:95]
    s_waitcnt vmcnt(10)
    ds_write_b128 v7, v[144:147] offset:28672
    ds_write_b128 v7, v[148:151] offset:28688
    ds_write_b128 v7, v[152:155] offset:28704
    ds_write_b128 v7, v[156:159] offset:28720
    ds_write_b128 v7, v[160:163] offset:28736
    ds_write_b128 v7, v[164:167] offset:28752
    s_waitcnt lgkmcnt(0)
    s_barrier
    s_mov_b32 s40, 384
    s_mov_b32 s41, 589824
    buffer_load_dwordx4 v[144:147], v8, s[16:19], s41 offen
    buffer_load_dwordx4 v[148:151], v9, s[16:19], s41 offen
    buffer_load_dwordx4 v[152:155], v10, s[16:19], s41 offen
    buffer_load_dwordx4 v[156:159], v11, s[16:19], s41 offen
    buffer_load_dwordx4 v[160:163], v12, s[16:19], s41 offen
    buffer_load_dwordx4 v[164:167], v13, s[16:19], s41 offen
    buffer_load_dwordx4 v[64:67], v3, s[12:15], s40 offen offset:0
    buffer_load_dwordx4 v[68:71], v3, s[12:15], s40 offen offset:16
    buffer_load_dwordx4 v[72:75], v3, s[12:15], s40 offen offset:32
    buffer_load_dwordx4 v[76:79], v3, s[12:15], s40 offen offset:48
    ds_read_b64_tr_b16 v[32:33], v20 offset:28672
    ds_read_b64_tr_b16 v[34:35], v20 offset:30464
    ds_read_b64_tr_b16 v[36:37], v20 offset:28736
    ds_read_b64_tr_b16 v[38:39], v20 offset:30528
    ds_read_b64_tr_b16 v[40:41], v20 offset:28800
    ds_read_b64_tr_b16 v[42:43], v20 offset:30592
    ds_read_b64_tr_b16 v[44:45], v20 offset:28864
    ds_read_b64_tr_b16 v[46:47], v20 offset:30656
    ds_read_b64_tr_b16 v[48:49], v20 offset:28928
    ds_read_b64_tr_b16 v[50:51], v20 offset:30720
    ds_read_b64_tr_b16 v[52:53], v20 offset:28992
    ds_read_b64_tr_b16 v[54:55], v20 offset:30784
    ds_read_b64_tr_b16 v[224:225], v20 offset:32256
    ds_read_b64_tr_b16 v[226:227], v20 offset:34048
    ds_read_b64_tr_b16 v[228:229], v20 offset:32320
    ds_read_b64_tr_b16 v[230:231], v20 offset:34112
    ds_read_b64_tr_b16 v[232:233], v20 offset:32384
    ds_read_b64_tr_b16 v[234:235], v20 offset:34176
    ds_read_b64_tr_b16 v[236:237], v20 offset:32448
    ds_read_b64_tr_b16 v[238:239], v20 offset:34240
    ds_read_b64_tr_b16 v[240:241], v20 offset:32512
    ds_read_b64_tr_b16 v[242:243], v20 offset:34304
    ds_read_b64_tr_b16 v[244:245], v20 offset:32576
    ds_read_b64_tr_b16 v[246:247], v20 offset:34368
    s_waitcnt lgkmcnt(12)
    v_mfma_f32_32x32x16_bf16 a[0:15], v[32:35], v[80:83], a[0:15]
    v_mfma_f32_32x32x16_bf16 a[16:31], v[36:39], v[80:83], a[16:31]
    v_mfma_f32_32x32x16_bf16 a[32:47], v[40:43], v[80:83], a[32:47]
    v_mfma_f32_32x32x16_bf16 a[48:63], v[44:47], v[80:83], a[48:63]
    v_mfma_f32_32x32x16_bf16 a[64:79], v[80:83], v[48:51], a[64:79]
    v_mfma_f32_32x32x16_bf16 a[80:95], v[80:83], v[52:55], a[80:95]
    ds_read_b64_tr_b16 v[32:33], v20 offset:35840
    ds_read_b64_tr_b16 v[34:35], v20 offset:37632
    ds_read_b64_tr_b16 v[36:37], v20 offset:35904
    ds_read_b64_tr_b16 v[38:39], v20 offset:37696
    ds_read_b64_tr_b16 v[40:41], v20 offset:35968
    ds_read_b64_tr_b16 v[42:43], v20 offset:37760
    ds_read_b64_tr_b16 v[44:45], v20 offset:36032
    ds_read_b64_tr_b16 v[46:47], v20 offset:37824
    ds_read_b64_tr_b16 v[48:49], v20 offset:36096
    ds_read_b64_tr_b16 v[50:51], v20 offset:37888
    ds_read_b64_tr_b16 v[52:53], v20 offset:36160
    ds_read_b64_tr_b16 v[54:55], v20 offset:37952
    s_waitcnt lgkmcnt(12)
    v_mfma_f32_32x32x16_bf16 a[0:15], v[224:227], v[84:87], a[0:15]
    v_mfma_f32_32x32x16_bf16 a[16:31], v[228:231], v[84:87], a[16:31]
    v_mfma_f32_32x32x16_bf16 a[32:47], v[232:235], v[84:87], a[32:47]
    v_mfma_f32_32x32x16_bf16 a[48:63], v[236:239], v[84:87], a[48:63]
    v_mfma_f32_32x32x16_bf16 a[64:79], v[84:87], v[240:243], a[64:79]
    v_mfma_f32_32x32x16_bf16 a[80:95], v[84:87], v[244:247], a[80:95]
    ds_read_b64_tr_b16 v[224:225], v20 offset:39424
    ds_read_b64_tr_b16 v[226:227], v20 offset:41216
    ds_read_b64_tr_b16 v[228:229], v20 offset:39488
    ds_read_b64_tr_b16 v[230:231], v20 offset:41280
    ds_read_b64_tr_b16 v[232:233], v20 offset:39552
    ds_read_b64_tr_b16 v[234:235], v20 offset:41344
    ds_read_b64_tr_b16 v[236:237], v20 offset:39616
    ds_read_b64_tr_b16 v[238:239], v20 offset:41408
    ds_read_b64_tr_b16 v[240:241], v20 offset:39680
    ds_read_b64_tr_b16 v[242:243], v20 offset:41472
    ds_read_b64_tr_b16 v[244:245], v20 offset:39744
    ds_read_b64_tr_b16 v[246:247], v20 offset:41536
    s_waitcnt lgkmcnt(12)
    v_mfma_f32_32x32x16_bf16 a[0:15], v[32:35], v[88:91], a[0:15]
    v_mfma_f32_32x32x16_bf16 a[16:31], v[36:39], v[88:91], a[16:31]
    v_mfma_f32_32x32x16_bf16 a[32:47], v[40:43], v[88:91], a[32:47]
    v_mfma_f32_32x32x16_bf16 a[48:63], v[44:47], v[88:91], a[48:63]
    v_mfma_f32_32x32x16_bf16 a[64:79], v[88:91], v[48:51], a[64:79]
    v_mfma_f32_32x32x16_bf16 a[80:95], v[88:91], v[52:55], a[80:95]
    s_waitcnt lgkmcnt(0)
    v_mfma_f32_32x32x16_bf16 a[0:15], v[224:227], v[92:95], a[0:15]
    v_mfma_f32_32x32x16_bf16 a[16:31], v[228:231], v[92:95], a[16:31]
    v_mfma_f32_32x32x16_bf16 a[32:47], v[232:235], v[92:95], a[32:47]
    v_mfma_f32_32x32x16_bf16 a[48:63], v[236:239], v[92:95], a[48:63]
    v_mfma_f32_32x32x16_bf16 a[64:79], v[92:95], v[240:243], a[64:79]
    v_mfma_f32_32x32x16_bf16 a[80:95], v[92:95], v[244:247], a[80:95]
    s_waitcnt vmcnt(10)
    ds_write_b128 v19, v[96:99] offset:0
    ds_write_b128 v19, v[100:103] offset:16
    ds_write_b128 v19, v[104:107] offset:32
    ds_write_b128 v19, v[108:111] offset:48
    ds_write_b128 v19, v[112:115] offset:64
    ds_write_b128 v19, v[116:119] offset:80
    s_waitcnt lgkmcnt(0)
    s_barrier
    s_mov_b32 s40, 512
    s_mov_b32 s41, 786432
    buffer_load_dwordx4 v[96:99], v8, s[16:19], s41 offen
    buffer_load_dwordx4 v[100:103], v9, s[16:19], s41 offen
    buffer_load_dwordx4 v[104:107], v10, s[16:19], s41 offen
    buffer_load_dwordx4 v[108:111], v11, s[16:19], s41 offen
    buffer_load_dwordx4 v[112:115], v12, s[16:19], s41 offen
    buffer_load_dwordx4 v[116:119], v13, s[16:19], s41 offen
    buffer_load_dwordx4 v[80:83], v3, s[12:15], s40 offen offset:0
    buffer_load_dwordx4 v[84:87], v3, s[12:15], s40 offen offset:16
    buffer_load_dwordx4 v[88:91], v3, s[12:15], s40 offen offset:32
    buffer_load_dwordx4 v[92:95], v3, s[12:15], s40 offen offset:48
    ds_read_b64_tr_b16 v[32:33], v6 offset:0
    ds_read_b64_tr_b16 v[34:35], v6 offset:1792
    ds_read_b64_tr_b16 v[36:37], v6 offset:64
    ds_read_b64_tr_b16 v[38:39], v6 offset:1856
    ds_read_b64_tr_b16 v[40:41], v6 offset:128
    ds_read_b64_tr_b16 v[42:43], v6 offset:1920
    ds_read_b64_tr_b16 v[44:45], v6 offset:192
    ds_read_b64_tr_b16 v[46:47], v6 offset:1984
    ds_read_b64_tr_b16 v[48:49], v6 offset:256
    ds_read_b64_tr_b16 v[50:51], v6 offset:2048
    ds_read_b64_tr_b16 v[52:53], v6 offset:320
    ds_read_b64_tr_b16 v[54:55], v6 offset:2112
    ds_read_b64_tr_b16 v[224:225], v6 offset:3584
    ds_read_b64_tr_b16 v[226:227], v6 offset:5376
    ds_read_b64_tr_b16 v[228:229], v6 offset:3648
    ds_read_b64_tr_b16 v[230:231], v6 offset:5440
    ds_read_b64_tr_b16 v[232:233], v6 offset:3712
    ds_read_b64_tr_b16 v[234:235], v6 offset:5504
    ds_read_b64_tr_b16 v[236:237], v6 offset:3776
    ds_read_b64_tr_b16 v[238:239], v6 offset:5568
    ds_read_b64_tr_b16 v[240:241], v6 offset:3840
    ds_read_b64_tr_b16 v[242:243], v6 offset:5632
    ds_read_b64_tr_b16 v[244:245], v6 offset:3904
    ds_read_b64_tr_b16 v[246:247], v6 offset:5696
    s_waitcnt lgkmcnt(12)
    v_mfma_f32_32x32x16_bf16 a[0:15], v[32:35], v[128:131], a[0:15]
    v_mfma_f32_32x32x16_bf16 a[16:31], v[36:39], v[128:131], a[16:31]
    v_mfma_f32_32x32x16_bf16 a[32:47], v[40:43], v[128:131], a[32:47]
    v_mfma_f32_32x32x16_bf16 a[48:63], v[44:47], v[128:131], a[48:63]
    v_mfma_f32_32x32x16_bf16 a[64:79], v[128:131], v[48:51], a[64:79]
    v_mfma_f32_32x32x16_bf16 a[80:95], v[128:131], v[52:55], a[80:95]
    ds_read_b64_tr_b16 v[32:33], v6 offset:7168
    ds_read_b64_tr_b16 v[34:35], v6 offset:8960
    ds_read_b64_tr_b16 v[36:37], v6 offset:7232
    ds_read_b64_tr_b16 v[38:39], v6 offset:9024
    ds_read_b64_tr_b16 v[40:41], v6 offset:7296
    ds_read_b64_tr_b16 v[42:43], v6 offset:9088
    ds_read_b64_tr_b16 v[44:45], v6 offset:7360
    ds_read_b64_tr_b16 v[46:47], v6 offset:9152
    ds_read_b64_tr_b16 v[48:49], v6 offset:7424
    ds_read_b64_tr_b16 v[50:51], v6 offset:9216
    ds_read_b64_tr_b16 v[52:53], v6 offset:7488
    ds_read_b64_tr_b16 v[54:55], v6 offset:9280
    s_waitcnt lgkmcnt(12)
    v_mfma_f32_32x32x16_bf16 a[0:15], v[224:227], v[132:135], a[0:15]
    v_mfma_f32_32x32x16_bf16 a[16:31], v[228:231], v[132:135], a[16:31]
    v_mfma_f32_32x32x16_bf16 a[32:47], v[232:235], v[132:135], a[32:47]
    v_mfma_f32_32x32x16_bf16 a[48:63], v[236:239], v[132:135], a[48:63]
    v_mfma_f32_32x32x16_bf16 a[64:79], v[132:135], v[240:243], a[64:79]
    v_mfma_f32_32x32x16_bf16 a[80:95], v[132:135], v[244:247], a[80:95]
    ds_read_b64_tr_b16 v[224:225], v6 offset:10752
    ds_read_b64_tr_b16 v[226:227], v6 offset:12544
    ds_read_b64_tr_b16 v[228:229], v6 offset:10816
    ds_read_b64_tr_b16 v[230:231], v6 offset:12608
    ds_read_b64_tr_b16 v[232:233], v6 offset:10880
    ds_read_b64_tr_b16 v[234:235], v6 offset:12672
    ds_read_b64_tr_b16 v[236:237], v6 offset:10944
    ds_read_b64_tr_b16 v[238:239], v6 offset:12736
    ds_read_b64_tr_b16 v[240:241], v6 offset:11008
    ds_read_b64_tr_b16 v[242:243], v6 offset:12800
    ds_read_b64_tr_b16 v[244:245], v6 offset:11072
    ds_read_b64_tr_b16 v[246:247], v6 offset:12864
    s_waitcnt lgkmcnt(12)
    v_mfma_f32_32x32x16_bf16 a[0:15], v[32:35], v[136:139], a[0:15]
    v_mfma_f32_32x32x16_bf16 a[16:31], v[36:39], v[136:139], a[16:31]
    v_mfma_f32_32x32x16_bf16 a[32:47], v[40:43], v[136:139], a[32:47]
    v_mfma_f32_32x32x16_bf16 a[48:63], v[44:47], v[136:139], a[48:63]
    v_mfma_f32_32x32x16_bf16 a[64:79], v[136:139], v[48:51], a[64:79]
    v_mfma_f32_32x32x16_bf16 a[80:95], v[136:139], v[52:55], a[80:95]
    s_waitcnt lgkmcnt(0)
    v_mfma_f32_32x32x16_bf16 a[0:15], v[224:227], v[140:143], a[0:15]
    v_mfma_f32_32x32x16_bf16 a[16:31], v[228:231], v[140:143], a[16:31]
    v_mfma_f32_32x32x16_bf16 a[32:47], v[232:235], v[140:143], a[32:47]
    v_mfma_f32_32x32x16_bf16 a[48:63], v[236:239], v[140:143], a[48:63]
    v_mfma_f32_32x32x16_bf16 a[64:79], v[140:143], v[240:243], a[64:79]
    v_mfma_f32_32x32x16_bf16 a[80:95], v[140:143], v[244:247], a[80:95]
    s_waitcnt vmcnt(10)
    ds_write_b128 v7, v[144:147] offset:0
    ds_write_b128 v7, v[148:151] offset:16
    ds_write_b128 v7, v[152:155] offset:32
    ds_write_b128 v7, v[156:159] offset:48
    ds_write_b128 v7, v[160:163] offset:64
    ds_write_b128 v7, v[164:167] offset:80
    s_waitcnt lgkmcnt(0)
    s_barrier
    s_mov_b32 s40, 640
    s_mov_b32 s41, 983040
    buffer_load_dwordx4 v[144:147], v8, s[16:19], s41 offen
    buffer_load_dwordx4 v[148:151], v9, s[16:19], s41 offen
    buffer_load_dwordx4 v[152:155], v10, s[16:19], s41 offen
    buffer_load_dwordx4 v[156:159], v11, s[16:19], s41 offen
    buffer_load_dwordx4 v[160:163], v12, s[16:19], s41 offen
    buffer_load_dwordx4 v[164:167], v13, s[16:19], s41 offen
    buffer_load_dwordx4 v[128:131], v3, s[12:15], s40 offen offset:0
    buffer_load_dwordx4 v[132:135], v3, s[12:15], s40 offen offset:16
    buffer_load_dwordx4 v[136:139], v3, s[12:15], s40 offen offset:32
    buffer_load_dwordx4 v[140:143], v3, s[12:15], s40 offen offset:48
    ds_read_b64_tr_b16 v[32:33], v20 offset:0
    ds_read_b64_tr_b16 v[34:35], v20 offset:1792
    ds_read_b64_tr_b16 v[36:37], v20 offset:64
    ds_read_b64_tr_b16 v[38:39], v20 offset:1856
    ds_read_b64_tr_b16 v[40:41], v20 offset:128
    ds_read_b64_tr_b16 v[42:43], v20 offset:1920
    ds_read_b64_tr_b16 v[44:45], v20 offset:192
    ds_read_b64_tr_b16 v[46:47], v20 offset:1984
    ds_read_b64_tr_b16 v[48:49], v20 offset:256
    ds_read_b64_tr_b16 v[50:51], v20 offset:2048
    ds_read_b64_tr_b16 v[52:53], v20 offset:320
    ds_read_b64_tr_b16 v[54:55], v20 offset:2112
    ds_read_b64_tr_b16 v[224:225], v20 offset:3584
    ds_read_b64_tr_b16 v[226:227], v20 offset:5376
    ds_read_b64_tr_b16 v[228:229], v20 offset:3648
    ds_read_b64_tr_b16 v[230:231], v20 offset:5440
    ds_read_b64_tr_b16 v[232:233], v20 offset:3712
    ds_read_b64_tr_b16 v[234:235], v20 offset:5504
    ds_read_b64_tr_b16 v[236:237], v20 offset:3776
    ds_read_b64_tr_b16 v[238:239], v20 offset:5568
    ds_read_b64_tr_b16 v[240:241], v20 offset:3840
    ds_read_b64_tr_b16 v[242:243], v20 offset:5632
    ds_read_b64_tr_b16 v[244:245], v20 offset:3904
    ds_read_b64_tr_b16 v[246:247], v20 offset:5696
    s_waitcnt lgkmcnt(12)
    v_mfma_f32_32x32x16_bf16 a[0:15], v[32:35], v[64:67], a[0:15]
    v_mfma_f32_32x32x16_bf16 a[16:31], v[36:39], v[64:67], a[16:31]
    v_mfma_f32_32x32x16_bf16 a[32:47], v[40:43], v[64:67], a[32:47]
    v_mfma_f32_32x32x16_bf16 a[48:63], v[44:47], v[64:67], a[48:63]
    v_mfma_f32_32x32x16_bf16 a[64:79], v[64:67], v[48:51], a[64:79]
    v_mfma_f32_32x32x16_bf16 a[80:95], v[64:67], v[52:55], a[80:95]
    ds_read_b64_tr_b16 v[32:33], v20 offset:7168
    ds_read_b64_tr_b16 v[34:35], v20 offset:8960
    ds_read_b64_tr_b16 v[36:37], v20 offset:7232
    ds_read_b64_tr_b16 v[38:39], v20 offset:9024
    ds_read_b64_tr_b16 v[40:41], v20 offset:7296
    ds_read_b64_tr_b16 v[42:43], v20 offset:9088
    ds_read_b64_tr_b16 v[44:45], v20 offset:7360
    ds_read_b64_tr_b16 v[46:47], v20 offset:9152
    ds_read_b64_tr_b16 v[48:49], v20 offset:7424
    ds_read_b64_tr_b16 v[50:51], v20 offset:9216
    ds_read_b64_tr_b16 v[52:53], v20 offset:7488
    ds_read_b64_tr_b16 v[54:55], v20 offset:9280
    s_waitcnt lgkmcnt(12)
    v_mfma_f32_32x32x16_bf16 a[0:15], v[224:227], v[68:71], a[0:15]
    v_mfma_f32_32x32x16_bf16 a[16:31], v[228:231], v[68:71], a[16:31]
    v_mfma_f32_32x32x16_bf16 a[32:47], v[232:235], v[68:71], a[32:47]
    v_mfma_f32_32x32x16_bf16 a[48:63], v[236:239], v[68:71], a[48:63]
    v_mfma_f32_32x32x16_bf16 a[64:79], v[68:71], v[240:243], a[64:79]
    v_mfma_f32_32x32x16_bf16 a[80:95], v[68:71], v[244:247], a[80:95]
    ds_read_b64_tr_b16 v[224:225], v20 offset:10752
    ds_read_b64_tr_b16 v[226:227], v20 offset:12544
    ds_read_b64_tr_b16 v[228:229], v20 offset:10816
    ds_read_b64_tr_b16 v[230:231], v20 offset:12608
    ds_read_b64_tr_b16 v[232:233], v20 offset:10880
    ds_read_b64_tr_b16 v[234:235], v20 offset:12672
    ds_read_b64_tr_b16 v[236:237], v20 offset:10944
    ds_read_b64_tr_b16 v[238:239], v20 offset:12736
    ds_read_b64_tr_b16 v[240:241], v20 offset:11008
    ds_read_b64_tr_b16 v[242:243], v20 offset:12800
    ds_read_b64_tr_b16 v[244:245], v20 offset:11072
    ds_read_b64_tr_b16 v[246:247], v20 offset:12864
    s_waitcnt lgkmcnt(12)
    v_mfma_f32_32x32x16_bf16 a[0:15], v[32:35], v[72:75], a[0:15]
    v_mfma_f32_32x32x16_bf16 a[16:31], v[36:39], v[72:75], a[16:31]
    v_mfma_f32_32x32x16_bf16 a[32:47], v[40:43], v[72:75], a[32:47]
    v_mfma_f32_32x32x16_bf16 a[48:63], v[44:47], v[72:75], a[48:63]
    v_mfma_f32_32x32x16_bf16 a[64:79], v[72:75], v[48:51], a[64:79]
    v_mfma_f32_32x32x16_bf16 a[80:95], v[72:75], v[52:55], a[80:95]
    s_waitcnt lgkmcnt(0)
    v_mfma_f32_32x32x16_bf16 a[0:15], v[224:227], v[76:79], a[0:15]
    v_mfma_f32_32x32x16_bf16 a[16:31], v[228:231], v[76:79], a[16:31]
    v_mfma_f32_32x32x16_bf16 a[32:47], v[232:235], v[76:79], a[32:47]
    v_mfma_f32_32x32x16_bf16 a[48:63], v[236:239], v[76:79], a[48:63]
    v_mfma_f32_32x32x16_bf16 a[64:79], v[76:79], v[240:243], a[64:79]
    v_mfma_f32_32x32x16_bf16 a[80:95], v[76:79], v[244:247], a[80:95]
    s_waitcnt vmcnt(10)
    ds_write_b128 v7, v[96:99] offset:28672
    ds_write_b128 v7, v[100:103] offset:28688
    ds_write_b128 v7, v[104:107] offset:28704
    ds_write_b128 v7, v[108:111] offset:28720
    ds_write_b128 v7, v[112:115] offset:28736
    ds_write_b128 v7, v[116:119] offset:28752
    s_waitcnt lgkmcnt(0)
    s_barrier
    s_mov_b32 s40, 768
    s_mov_b32 s41, 1179648
    buffer_load_dwordx4 v[96:99], v8, s[16:19], s41 offen
    buffer_load_dwordx4 v[100:103], v9, s[16:19], s41 offen
    buffer_load_dwordx4 v[104:107], v10, s[16:19], s41 offen
    buffer_load_dwordx4 v[108:111], v11, s[16:19], s41 offen
    buffer_load_dwordx4 v[112:115], v12, s[16:19], s41 offen
    buffer_load_dwordx4 v[116:119], v13, s[16:19], s41 offen
    buffer_load_dwordx4 v[64:67], v3, s[12:15], s40 offen offset:0
    buffer_load_dwordx4 v[68:71], v3, s[12:15], s40 offen offset:16
    buffer_load_dwordx4 v[72:75], v3, s[12:15], s40 offen offset:32
    buffer_load_dwordx4 v[76:79], v3, s[12:15], s40 offen offset:48
    ds_read_b64_tr_b16 v[32:33], v20 offset:28672
    ds_read_b64_tr_b16 v[34:35], v20 offset:30464
    ds_read_b64_tr_b16 v[36:37], v20 offset:28736
    ds_read_b64_tr_b16 v[38:39], v20 offset:30528
    ds_read_b64_tr_b16 v[40:41], v20 offset:28800
    ds_read_b64_tr_b16 v[42:43], v20 offset:30592
    ds_read_b64_tr_b16 v[44:45], v20 offset:28864
    ds_read_b64_tr_b16 v[46:47], v20 offset:30656
    ds_read_b64_tr_b16 v[48:49], v20 offset:28928
    ds_read_b64_tr_b16 v[50:51], v20 offset:30720
    ds_read_b64_tr_b16 v[52:53], v20 offset:28992
    ds_read_b64_tr_b16 v[54:55], v20 offset:30784
    ds_read_b64_tr_b16 v[224:225], v20 offset:32256
    ds_read_b64_tr_b16 v[226:227], v20 offset:34048
    ds_read_b64_tr_b16 v[228:229], v20 offset:32320
    ds_read_b64_tr_b16 v[230:231], v20 offset:34112
    ds_read_b64_tr_b16 v[232:233], v20 offset:32384
    ds_read_b64_tr_b16 v[234:235], v20 offset:34176
    ds_read_b64_tr_b16 v[236:237], v20 offset:32448
    ds_read_b64_tr_b16 v[238:239], v20 offset:34240
    ds_read_b64_tr_b16 v[240:241], v20 offset:32512
    ds_read_b64_tr_b16 v[242:243], v20 offset:34304
    ds_read_b64_tr_b16 v[244:245], v20 offset:32576
    ds_read_b64_tr_b16 v[246:247], v20 offset:34368
    s_waitcnt lgkmcnt(12)
    v_mfma_f32_32x32x16_bf16 a[0:15], v[32:35], v[80:83], a[0:15]
    v_mfma_f32_32x32x16_bf16 a[16:31], v[36:39], v[80:83], a[16:31]
    v_mfma_f32_32x32x16_bf16 a[32:47], v[40:43], v[80:83], a[32:47]
    v_mfma_f32_32x32x16_bf16 a[48:63], v[44:47], v[80:83], a[48:63]
    v_mfma_f32_32x32x16_bf16 a[64:79], v[80:83], v[48:51], a[64:79]
    v_mfma_f32_32x32x16_bf16 a[80:95], v[80:83], v[52:55], a[80:95]
    ds_read_b64_tr_b16 v[32:33], v20 offset:35840
    ds_read_b64_tr_b16 v[34:35], v20 offset:37632
    ds_read_b64_tr_b16 v[36:37], v20 offset:35904
    ds_read_b64_tr_b16 v[38:39], v20 offset:37696
    ds_read_b64_tr_b16 v[40:41], v20 offset:35968
    ds_read_b64_tr_b16 v[42:43], v20 offset:37760
    ds_read_b64_tr_b16 v[44:45], v20 offset:36032
    ds_read_b64_tr_b16 v[46:47], v20 offset:37824
    ds_read_b64_tr_b16 v[48:49], v20 offset:36096
    ds_read_b64_tr_b16 v[50:51], v20 offset:37888
    ds_read_b64_tr_b16 v[52:53], v20 offset:36160
    ds_read_b64_tr_b16 v[54:55], v20 offset:37952
    s_waitcnt lgkmcnt(12)
    v_mfma_f32_32x32x16_bf16 a[0:15], v[224:227], v[84:87], a[0:15]
    v_mfma_f32_32x32x16_bf16 a[16:31], v[228:231], v[84:87], a[16:31]
    v_mfma_f32_32x32x16_bf16 a[32:47], v[232:235], v[84:87], a[32:47]
    v_mfma_f32_32x32x16_bf16 a[48:63], v[236:239], v[84:87], a[48:63]
    v_mfma_f32_32x32x16_bf16 a[64:79], v[84:87], v[240:243], a[64:79]
    v_mfma_f32_32x32x16_bf16 a[80:95], v[84:87], v[244:247], a[80:95]
    ds_read_b64_tr_b16 v[224:225], v20 offset:39424
    ds_read_b64_tr_b16 v[226:227], v20 offset:41216
    ds_read_b64_tr_b16 v[228:229], v20 offset:39488
    ds_read_b64_tr_b16 v[230:231], v20 offset:41280
    ds_read_b64_tr_b16 v[232:233], v20 offset:39552
    ds_read_b64_tr_b16 v[234:235], v20 offset:41344
    ds_read_b64_tr_b16 v[236:237], v20 offset:39616
    ds_read_b64_tr_b16 v[238:239], v20 offset:41408
    ds_read_b64_tr_b16 v[240:241], v20 offset:39680
    ds_read_b64_tr_b16 v[242:243], v20 offset:41472
    ds_read_b64_tr_b16 v[244:245], v20 offset:39744
    ds_read_b64_tr_b16 v[246:247], v20 offset:41536
    s_waitcnt lgkmcnt(12)
    v_mfma_f32_32x32x16_bf16 a[0:15], v[32:35], v[88:91], a[0:15]
    v_mfma_f32_32x32x16_bf16 a[16:31], v[36:39], v[88:91], a[16:31]
    v_mfma_f32_32x32x16_bf16 a[32:47], v[40:43], v[88:91], a[32:47]
    v_mfma_f32_32x32x16_bf16 a[48:63], v[44:47], v[88:91], a[48:63]
    v_mfma_f32_32x32x16_bf16 a[64:79], v[88:91], v[48:51], a[64:79]
    v_mfma_f32_32x32x16_bf16 a[80:95], v[88:91], v[52:55], a[80:95]
    s_waitcnt lgkmcnt(0)
    v_mfma_f32_32x32x16_bf16 a[0:15], v[224:227], v[92:95], a[0:15]
    v_mfma_f32_32x32x16_bf16 a[16:31], v[228:231], v[92:95], a[16:31]
    v_mfma_f32_32x32x16_bf16 a[32:47], v[232:235], v[92:95], a[32:47]
    v_mfma_f32_32x32x16_bf16 a[48:63], v[236:239], v[92:95], a[48:63]
    v_mfma_f32_32x32x16_bf16 a[64:79], v[92:95], v[240:243], a[64:79]
    v_mfma_f32_32x32x16_bf16 a[80:95], v[92:95], v[244:247], a[80:95]
    s_waitcnt vmcnt(10)
    ds_write_b128 v19, v[144:147] offset:0
    ds_write_b128 v19, v[148:151] offset:16
    ds_write_b128 v19, v[152:155] offset:32
    ds_write_b128 v19, v[156:159] offset:48
    ds_write_b128 v19, v[160:163] offset:64
    ds_write_b128 v19, v[164:167] offset:80
    s_waitcnt lgkmcnt(0)
    s_barrier
    s_mov_b32 s40, 896
    s_mov_b32 s41, 1376256
    buffer_load_dwordx4 v[144:147], v8, s[16:19], s41 offen
    buffer_load_dwordx4 v[148:151], v9, s[16:19], s41 offen
    buffer_load_dwordx4 v[152:155], v10, s[16:19], s41 offen
    buffer_load_dwordx4 v[156:159], v11, s[16:19], s41 offen
    buffer_load_dwordx4 v[160:163], v12, s[16:19], s41 offen
    buffer_load_dwordx4 v[164:167], v13, s[16:19], s41 offen
    buffer_load_dwordx4 v[80:83], v3, s[12:15], s40 offen offset:0
    buffer_load_dwordx4 v[84:87], v3, s[12:15], s40 offen offset:16
    buffer_load_dwordx4 v[88:91], v3, s[12:15], s40 offen offset:32
    buffer_load_dwordx4 v[92:95], v3, s[12:15], s40 offen offset:48
    ds_read_b64_tr_b16 v[32:33], v6 offset:0
    ds_read_b64_tr_b16 v[34:35], v6 offset:1792
    ds_read_b64_tr_b16 v[36:37], v6 offset:64
    ds_read_b64_tr_b16 v[38:39], v6 offset:1856
    ds_read_b64_tr_b16 v[40:41], v6 offset:128
    ds_read_b64_tr_b16 v[42:43], v6 offset:1920
    ds_read_b64_tr_b16 v[44:45], v6 offset:192
    ds_read_b64_tr_b16 v[46:47], v6 offset:1984
    ds_read_b64_tr_b16 v[48:49], v6 offset:256
    ds_read_b64_tr_b16 v[50:51], v6 offset:2048
    ds_read_b64_tr_b16 v[52:53], v6 offset:320
    ds_read_b64_tr_b16 v[54:55], v6 offset:2112
    ds_read_b64_tr_b16 v[224:225], v6 offset:3584
    ds_read_b64_tr_b16 v[226:227], v6 offset:5376
    ds_read_b64_tr_b16 v[228:229], v6 offset:3648
    ds_read_b64_tr_b16 v[230:231], v6 offset:5440
    ds_read_b64_tr_b16 v[232:233], v6 offset:3712
    ds_read_b64_tr_b16 v[234:235], v6 offset:5504
    ds_read_b64_tr_b16 v[236:237], v6 offset:3776
    ds_read_b64_tr_b16 v[238:239], v6 offset:5568
    ds_read_b64_tr_b16 v[240:241], v6 offset:3840
    ds_read_b64_tr_b16 v[242:243], v6 offset:5632
    ds_read_b64_tr_b16 v[244:245], v6 offset:3904
    ds_read_b64_tr_b16 v[246:247], v6 offset:5696
    s_waitcnt lgkmcnt(12)
    v_mfma_f32_32x32x16_bf16 a[0:15], v[32:35], v[128:131], a[0:15]
    v_mfma_f32_32x32x16_bf16 a[16:31], v[36:39], v[128:131], a[16:31]
    v_mfma_f32_32x32x16_bf16 a[32:47], v[40:43], v[128:131], a[32:47]
    v_mfma_f32_32x32x16_bf16 a[48:63], v[44:47], v[128:131], a[48:63]
    v_mfma_f32_32x32x16_bf16 a[64:79], v[128:131], v[48:51], a[64:79]
    v_mfma_f32_32x32x16_bf16 a[80:95], v[128:131], v[52:55], a[80:95]
    ds_read_b64_tr_b16 v[32:33], v6 offset:7168
    ds_read_b64_tr_b16 v[34:35], v6 offset:8960
    ds_read_b64_tr_b16 v[36:37], v6 offset:7232
    ds_read_b64_tr_b16 v[38:39], v6 offset:9024
    ds_read_b64_tr_b16 v[40:41], v6 offset:7296
    ds_read_b64_tr_b16 v[42:43], v6 offset:9088
    ds_read_b64_tr_b16 v[44:45], v6 offset:7360
    ds_read_b64_tr_b16 v[46:47], v6 offset:9152
    ds_read_b64_tr_b16 v[48:49], v6 offset:7424
    ds_read_b64_tr_b16 v[50:51], v6 offset:9216
    ds_read_b64_tr_b16 v[52:53], v6 offset:7488
    ds_read_b64_tr_b16 v[54:55], v6 offset:9280
    s_waitcnt lgkmcnt(12)
    v_mfma_f32_32x32x16_bf16 a[0:15], v[224:227], v[132:135], a[0:15]
    v_mfma_f32_32x32x16_bf16 a[16:31], v[228:231], v[132:135], a[16:31]
    v_mfma_f32_32x32x16_bf16 a[32:47], v[232:235], v[132:135], a[32:47]
    v_mfma_f32_32x32x16_bf16 a[48:63], v[236:239], v[132:135], a[48:63]
    v_mfma_f32_32x32x16_bf16 a[64:79], v[132:135], v[240:243], a[64:79]
    v_mfma_f32_32x32x16_bf16 a[80:95], v[132:135], v[244:247], a[80:95]
    ds_read_b64_tr_b16 v[224:225], v6 offset:10752
    ds_read_b64_tr_b16 v[226:227], v6 offset:12544
    ds_read_b64_tr_b16 v[228:229], v6 offset:10816
    ds_read_b64_tr_b16 v[230:231], v6 offset:12608
    ds_read_b64_tr_b16 v[232:233], v6 offset:10880
    ds_read_b64_tr_b16 v[234:235], v6 offset:12672
    ds_read_b64_tr_b16 v[236:237], v6 offset:10944
    ds_read_b64_tr_b16 v[238:239], v6 offset:12736
    ds_read_b64_tr_b16 v[240:241], v6 offset:11008
    ds_read_b64_tr_b16 v[242:243], v6 offset:12800
    ds_read_b64_tr_b16 v[244:245], v6 offset:11072
    ds_read_b64_tr_b16 v[246:247], v6 offset:12864
    s_waitcnt lgkmcnt(12)
    v_mfma_f32_32x32x16_bf16 a[0:15], v[32:35], v[136:139], a[0:15]
    v_mfma_f32_32x32x16_bf16 a[16:31], v[36:39], v[136:139], a[16:31]
    v_mfma_f32_32x32x16_bf16 a[32:47], v[40:43], v[136:139], a[32:47]
    v_mfma_f32_32x32x16_bf16 a[48:63], v[44:47], v[136:139], a[48:63]
    v_mfma_f32_32x32x16_bf16 a[64:79], v[136:139], v[48:51], a[64:79]
    v_mfma_f32_32x32x16_bf16 a[80:95], v[136:139], v[52:55], a[80:95]
    s_waitcnt lgkmcnt(0)
    v_mfma_f32_32x32x16_bf16 a[0:15], v[224:227], v[140:143], a[0:15]
    v_mfma_f32_32x32x16_bf16 a[16:31], v[228:231], v[140:143], a[16:31]
    v_mfma_f32_32x32x16_bf16 a[32:47], v[232:235], v[140:143], a[32:47]
    v_mfma_f32_32x32x16_bf16 a[48:63], v[236:239], v[140:143], a[48:63]
    v_mfma_f32_32x32x16_bf16 a[64:79], v[140:143], v[240:243], a[64:79]
    v_mfma_f32_32x32x16_bf16 a[80:95], v[140:143], v[244:247], a[80:95]
    s_waitcnt vmcnt(10)
    ds_write_b128 v7, v[96:99] offset:0
    ds_write_b128 v7, v[100:103] offset:16
    ds_write_b128 v7, v[104:107] offset:32
    ds_write_b128 v7, v[108:111] offset:48
    ds_write_b128 v7, v[112:115] offset:64
    ds_write_b128 v7, v[116:119] offset:80
    s_waitcnt lgkmcnt(0)
    s_barrier
    ds_read_b64_tr_b16 v[32:33], v20 offset:0
    ds_read_b64_tr_b16 v[34:35], v20 offset:1792
    ds_read_b64_tr_b16 v[36:37], v20 offset:64
    ds_read_b64_tr_b16 v[38:39], v20 offset:1856
    ds_read_b64_tr_b16 v[40:41], v20 offset:128
    ds_read_b64_tr_b16 v[42:43], v20 offset:1920
    ds_read_b64_tr_b16 v[44:45], v20 offset:192
    ds_read_b64_tr_b16 v[46:47], v20 offset:1984
    ds_read_b64_tr_b16 v[48:49], v20 offset:256
    ds_read_b64_tr_b16 v[50:51], v20 offset:2048
    ds_read_b64_tr_b16 v[52:53], v20 offset:320
    ds_read_b64_tr_b16 v[54:55], v20 offset:2112
    ds_read_b64_tr_b16 v[224:225], v20 offset:3584
    ds_read_b64_tr_b16 v[226:227], v20 offset:5376
    ds_read_b64_tr_b16 v[228:229], v20 offset:3648
    ds_read_b64_tr_b16 v[230:231], v20 offset:5440
    ds_read_b64_tr_b16 v[232:233], v20 offset:3712
    ds_read_b64_tr_b16 v[234:235], v20 offset:5504
    ds_read_b64_tr_b16 v[236:237], v20 offset:3776
    ds_read_b64_tr_b16 v[238:239], v20 offset:5568
    ds_read_b64_tr_b16 v[240:241], v20 offset:3840
    ds_read_b64_tr_b16 v[242:243], v20 offset:5632
    ds_read_b64_tr_b16 v[244:245], v20 offset:3904
    ds_read_b64_tr_b16 v[246:247], v20 offset:5696
    s_waitcnt lgkmcnt(12)
    v_mfma_f32_32x32x16_bf16 a[0:15], v[32:35], v[64:67], a[0:15]
    v_mfma_f32_32x32x16_bf16 a[16:31], v[36:39], v[64:67], a[16:31]
    v_mfma_f32_32x32x16_bf16 a[32:47], v[40:43], v[64:67], a[32:47]
    v_mfma_f32_32x32x16_bf16 a[48:63], v[44:47], v[64:67], a[48:63]
    v_mfma_f32_32x32x16_bf16 a[64:79], v[64:67], v[48:51], a[64:79]
    v_mfma_f32_32x32x16_bf16 a[80:95], v[64:67], v[52:55], a[80:95]
    ds_read_b64_tr_b16 v[32:33], v20 offset:7168
    ds_read_b64_tr_b16 v[34:35], v20 offset:8960
    ds_read_b64_tr_b16 v[36:37], v20 offset:7232
    ds_read_b64_tr_b16 v[38:39], v20 offset:9024
    ds_read_b64_tr_b16 v[40:41], v20 offset:7296
    ds_read_b64_tr_b16 v[42:43], v20 offset:9088
    ds_read_b64_tr_b16 v[44:45], v20 offset:7360
    ds_read_b64_tr_b16 v[46:47], v20 offset:9152
    ds_read_b64_tr_b16 v[48:49], v20 offset:7424
    ds_read_b64_tr_b16 v[50:51], v20 offset:9216
    ds_read_b64_tr_b16 v[52:53], v20 offset:7488
    ds_read_b64_tr_b16 v[54:55], v20 offset:9280
    s_waitcnt lgkmcnt(12)
    v_mfma_f32_32x32x16_bf16 a[0:15], v[224:227], v[68:71], a[0:15]
    v_mfma_f32_32x32x16_bf16 a[16:31], v[228:231], v[68:71], a[16:31]
    v_mfma_f32_32x32x16_bf16 a[32:47], v[232:235], v[68:71], a[32:47]
    v_mfma_f32_32x32x16_bf16 a[48:63], v[236:239], v[68:71], a[48:63]
    v_mfma_f32_32x32x16_bf16 a[64:79], v[68:71], v[240:243], a[64:79]
    v_mfma_f32_32x32x16_bf16 a[80:95], v[68:71], v[244:247], a[80:95]
    ds_read_b64_tr_b16 v[224:225], v20 offset:10752
    ds_read_b64_tr_b16 v[226:227], v20 offset:12544
    ds_read_b64_tr_b16 v[228:229], v20 offset:10816
    ds_read_b64_tr_b16 v[230:231], v20 offset:12608
    ds_read_b64_tr_b16 v[232:233], v20 offset:10880
    ds_read_b64_tr_b16 v[234:235], v20 offset:12672
    ds_read_b64_tr_b16 v[236:237], v20 offset:10944
    ds_read_b64_tr_b16 v[238:239], v20 offset:12736
    ds_read_b64_tr_b16 v[240:241], v20 offset:11008
    ds_read_b64_tr_b16 v[242:243], v20 offset:12800
    ds_read_b64_tr_b16 v[244:245], v20 offset:11072
    ds_read_b64_tr_b16 v[246:247], v20 offset:12864
    s_waitcnt lgkmcnt(12)
    v_mfma_f32_32x32x16_bf16 a[0:15], v[32:35], v[72:75], a[0:15]
    v_mfma_f32_32x32x16_bf16 a[16:31], v[36:39], v[72:75], a[16:31]
    v_mfma_f32_32x32x16_bf16 a[32:47], v[40:43], v[72:75], a[32:47]
    v_mfma_f32_32x32x16_bf16 a[48:63], v[44:47], v[72:75], a[48:63]
    v_mfma_f32_32x32x16_bf16 a[64:79], v[72:75], v[48:51], a[64:79]
    v_mfma_f32_32x32x16_bf16 a[80:95], v[72:75], v[52:55], a[80:95]
    s_waitcnt lgkmcnt(0)
    v_mfma_f32_32x32x16_bf16 a[0:15], v[224:227], v[76:79], a[0:15]
    v_mfma_f32_32x32x16_bf16 a[16:31], v[228:231], v[76:79], a[16:31]
    v_mfma_f32_32x32x16_bf16 a[32:47], v[232:235], v[76:79], a[32:47]
    v_mfma_f32_32x32x16_bf16 a[48:63], v[236:239], v[76:79], a[48:63]
    v_mfma_f32_32x32x16_bf16 a[64:79], v[76:79], v[240:243], a[64:79]
    v_mfma_f32_32x32x16_bf16 a[80:95], v[76:79], v[244:247], a[80:95]
    s_waitcnt vmcnt(0)
    ds_write_b128 v7, v[144:147] offset:28672
    ds_write_b128 v7, v[148:151] offset:28688
    ds_write_b128 v7, v[152:155] offset:28704
    ds_write_b128 v7, v[156:159] offset:28720
    ds_write_b128 v7, v[160:163] offset:28736
    ds_write_b128 v7, v[164:167] offset:28752
    s_waitcnt lgkmcnt(0)
    s_barrier
    ds_read_b64_tr_b16 v[32:33], v20 offset:28672
    ds_read_b64_tr_b16 v[34:35], v20 offset:30464
    ds_read_b64_tr_b16 v[36:37], v20 offset:28736
    ds_read_b64_tr_b16 v[38:39], v20 offset:30528
    ds_read_b64_tr_b16 v[40:41], v20 offset:28800
    ds_read_b64_tr_b16 v[42:43], v20 offset:30592
    ds_read_b64_tr_b16 v[44:45], v20 offset:28864
    ds_read_b64_tr_b16 v[46:47], v20 offset:30656
    ds_read_b64_tr_b16 v[48:49], v20 offset:28928
    ds_read_b64_tr_b16 v[50:51], v20 offset:30720
    ds_read_b64_tr_b16 v[52:53], v20 offset:28992
    ds_read_b64_tr_b16 v[54:55], v20 offset:30784
    ds_read_b64_tr_b16 v[224:225], v20 offset:32256
    ds_read_b64_tr_b16 v[226:227], v20 offset:34048
    ds_read_b64_tr_b16 v[228:229], v20 offset:32320
    ds_read_b64_tr_b16 v[230:231], v20 offset:34112
    ds_read_b64_tr_b16 v[232:233], v20 offset:32384
    ds_read_b64_tr_b16 v[234:235], v20 offset:34176
    ds_read_b64_tr_b16 v[236:237], v20 offset:32448
    ds_read_b64_tr_b16 v[238:239], v20 offset:34240
    ds_read_b64_tr_b16 v[240:241], v20 offset:32512
    ds_read_b64_tr_b16 v[242:243], v20 offset:34304
    ds_read_b64_tr_b16 v[244:245], v20 offset:32576
    ds_read_b64_tr_b16 v[246:247], v20 offset:34368
    s_waitcnt lgkmcnt(12)
    v_mfma_f32_32x32x16_bf16 a[0:15], v[32:35], v[80:83], a[0:15]
    v_mfma_f32_32x32x16_bf16 a[16:31], v[36:39], v[80:83], a[16:31]
    v_mfma_f32_32x32x16_bf16 a[32:47], v[40:43], v[80:83], a[32:47]
    v_mfma_f32_32x32x16_bf16 a[48:63], v[44:47], v[80:83], a[48:63]
    v_mfma_f32_32x32x16_bf16 a[64:79], v[80:83], v[48:51], a[64:79]
    v_mfma_f32_32x32x16_bf16 a[80:95], v[80:83], v[52:55], a[80:95]
    ds_read_b64_tr_b16 v[32:33], v20 offset:35840
    ds_read_b64_tr_b16 v[34:35], v20 offset:37632
    ds_read_b64_tr_b16 v[36:37], v20 offset:35904
    ds_read_b64_tr_b16 v[38:39], v20 offset:37696
    ds_read_b64_tr_b16 v[40:41], v20 offset:35968
    ds_read_b64_tr_b16 v[42:43], v20 offset:37760
    ds_read_b64_tr_b16 v[44:45], v20 offset:36032
    ds_read_b64_tr_b16 v[46:47], v20 offset:37824
    ds_read_b64_tr_b16 v[48:49], v20 offset:36096
    ds_read_b64_tr_b16 v[50:51], v20 offset:37888
    ds_read_b64_tr_b16 v[52:53], v20 offset:36160
    ds_read_b64_tr_b16 v[54:55], v20 offset:37952
    s_waitcnt lgkmcnt(12)
    v_mfma_f32_32x32x16_bf16 a[0:15], v[224:227], v[84:87], a[0:15]
    v_mfma_f32_32x32x16_bf16 a[16:31], v[228:231], v[84:87], a[16:31]
    v_mfma_f32_32x32x16_bf16 a[32:47], v[232:235], v[84:87], a[32:47]
    v_mfma_f32_32x32x16_bf16 a[48:63], v[236:239], v[84:87], a[48:63]
    v_mfma_f32_32x32x16_bf16 a[64:79], v[84:87], v[240:243], a[64:79]
    v_mfma_f32_32x32x16_bf16 a[80:95], v[84:87], v[244:247], a[80:95]
    ds_read_b64_tr_b16 v[224:225], v20 offset:39424
    ds_read_b64_tr_b16 v[226:227], v20 offset:41216
    ds_read_b64_tr_b16 v[228:229], v20 offset:39488
    ds_read_b64_tr_b16 v[230:231], v20 offset:41280
    ds_read_b64_tr_b16 v[232:233], v20 offset:39552
    ds_read_b64_tr_b16 v[234:235], v20 offset:41344
    ds_read_b64_tr_b16 v[236:237], v20 offset:39616
    ds_read_b64_tr_b16 v[238:239], v20 offset:41408
    ds_read_b64_tr_b16 v[240:241], v20 offset:39680
    ds_read_b64_tr_b16 v[242:243], v20 offset:41472
    ds_read_b64_tr_b16 v[244:245], v20 offset:39744
    ds_read_b64_tr_b16 v[246:247], v20 offset:41536
    s_waitcnt lgkmcnt(12)
    v_mfma_f32_32x32x16_bf16 a[0:15], v[32:35], v[88:91], a[0:15]
    v_mfma_f32_32x32x16_bf16 a[16:31], v[36:39], v[88:91], a[16:31]
    v_mfma_f32_32x32x16_bf16 a[32:47], v[40:43], v[88:91], a[32:47]
    v_mfma_f32_32x32x16_bf16 a[48:63], v[44:47], v[88:91], a[48:63]
    v_mfma_f32_32x32x16_bf16 a[64:79], v[88:91], v[48:51], a[64:79]
    v_mfma_f32_32x32x16_bf16 a[80:95], v[88:91], v[52:55], a[80:95]
    s_waitcnt lgkmcnt(0)
    v_mfma_f32_32x32x16_bf16 a[0:15], v[224:227], v[92:95], a[0:15]
    v_mfma_f32_32x32x16_bf16 a[16:31], v[228:231], v[92:95], a[16:31]
    v_mfma_f32_32x32x16_bf16 a[32:47], v[232:235], v[92:95], a[32:47]
    v_mfma_f32_32x32x16_bf16 a[48:63], v[236:239], v[92:95], a[48:63]
    v_mfma_f32_32x32x16_bf16 a[64:79], v[92:95], v[240:243], a[64:79]
    v_mfma_f32_32x32x16_bf16 a[80:95], v[92:95], v[244:247], a[80:95]
    s_nop 15
    v_accvgpr_read_b32 v128, a0
    v_accvgpr_read_b32 v129, a1
    v_accvgpr_read_b32 v130, a2
    v_accvgpr_read_b32 v131, a3
    v_accvgpr_read_b32 v132, a4
    v_accvgpr_read_b32 v133, a5
    v_accvgpr_read_b32 v134, a6
    v_accvgpr_read_b32 v135, a7
    v_accvgpr_read_b32 v136, a8
    v_accvgpr_read_b32 v137, a9
    v_accvgpr_read_b32 v138, a10
    v_accvgpr_read_b32 v139, a11
    v_accvgpr_read_b32 v140, a12
    v_accvgpr_read_b32 v141, a13
    v_accvgpr_read_b32 v142, a14
    v_accvgpr_read_b32 v143, a15
    v_accvgpr_read_b32 v144, a16
    v_accvgpr_read_b32 v145, a17
    v_accvgpr_read_b32 v146, a18
    v_accvgpr_read_b32 v147, a19
    v_accvgpr_read_b32 v148, a20
    v_accvgpr_read_b32 v149, a21
    v_accvgpr_read_b32 v150, a22
    v_accvgpr_read_b32 v151, a23
    v_accvgpr_read_b32 v152, a24
    v_accvgpr_read_b32 v153, a25
    v_accvgpr_read_b32 v154, a26
    v_accvgpr_read_b32 v155, a27
    v_accvgpr_read_b32 v156, a28
    v_accvgpr_read_b32 v157, a29
    v_accvgpr_read_b32 v158, a30
    v_accvgpr_read_b32 v159, a31
    v_accvgpr_read_b32 v160, a32
    v_accvgpr_read_b32 v161, a33
    v_accvgpr_read_b32 v162, a34
    v_accvgpr_read_b32 v163, a35
    v_accvgpr_read_b32 v164, a36
    v_accvgpr_read_b32 v165, a37
    v_accvgpr_read_b32 v166, a38
    v_accvgpr_read_b32 v167, a39
    v_accvgpr_read_b32 v168, a40
    v_accvgpr_read_b32 v169, a41
    v_accvgpr_read_b32 v170, a42
    v_accvgpr_read_b32 v171, a43
    v_accvgpr_read_b32 v172, a44
    v_accvgpr_read_b32 v173, a45
    v_accvgpr_read_b32 v174, a46
    v_accvgpr_read_b32 v175, a47
    v_accvgpr_read_b32 v176, a48
    v_accvgpr_read_b32 v177, a49
    v_accvgpr_read_b32 v178, a50
    v_accvgpr_read_b32 v179, a51
    v_accvgpr_read_b32 v180, a52
    v_accvgpr_read_b32 v181, a53
    v_accvgpr_read_b32 v182, a54
    v_accvgpr_read_b32 v183, a55
    v_accvgpr_read_b32 v184, a56
    v_accvgpr_read_b32 v185, a57
    v_accvgpr_read_b32 v186, a58
    v_accvgpr_read_b32 v187, a59
    v_accvgpr_read_b32 v188, a60
    v_accvgpr_read_b32 v189, a61
    v_accvgpr_read_b32 v190, a62
    v_accvgpr_read_b32 v191, a63
    v_accvgpr_read_b32 v192, a64
    v_accvgpr_read_b32 v193, a65
    v_accvgpr_read_b32 v194, a66
    v_accvgpr_read_b32 v195, a67
    v_accvgpr_read_b32 v196, a68
    v_accvgpr_read_b32 v197, a69
    v_accvgpr_read_b32 v198, a70
    v_accvgpr_read_b32 v199, a71
    v_accvgpr_read_b32 v200, a72
    v_accvgpr_read_b32 v201, a73
    v_accvgpr_read_b32 v202, a74
    v_accvgpr_read_b32 v203, a75
    v_accvgpr_read_b32 v204, a76
    v_accvgpr_read_b32 v205, a77
    v_accvgpr_read_b32 v206, a78
    v_accvgpr_read_b32 v207, a79
    v_accvgpr_read_b32 v208, a80
    v_accvgpr_read_b32 v209, a81
    v_accvgpr_read_b32 v210, a82
    v_accvgpr_read_b32 v211, a83
    v_accvgpr_read_b32 v212, a84
    v_accvgpr_read_b32 v213, a85
    v_accvgpr_read_b32 v214, a86
    v_accvgpr_read_b32 v215, a87
    v_accvgpr_read_b32 v216, a88
    v_accvgpr_read_b32 v217, a89
    v_accvgpr_read_b32 v218, a90
    v_accvgpr_read_b32 v219, a91
    v_accvgpr_read_b32 v220, a92
    v_accvgpr_read_b32 v221, a93
    v_accvgpr_read_b32 v222, a94
    v_accvgpr_read_b32 v223, a95
    s_cmp_ge_u32 s30, 4
    s_mov_b32 s42, 0x3eb8aa3b
    s_cselect_b32 s42, 1.0, s42
    s_cselect_b32 s43, 1, 0
    v_lshlrev_b32 v21, 5, v4
    v_lshl_add_u32 v21, v5, 3, v21
    s_lshl_b32 s44, s43, 22
    s_lshl_b32 s45, s24, 5
    s_and_b32 s46, s30, 3
    s_lshl_b32 s46, s46, 3
    s_add_u32 s45, s45, s46
    s_lshl_b32 s45, s45, 11
    s_add_u32 s45, s45, s32
    s_lshl_b32 s45, s45, 5
    s_add_u32 s44, s44, s45
    v_mul_f32 v128, s42, v128
    v_mul_f32 v129, s42, v129
    v_mul_f32 v130, s42, v130
    v_mul_f32 v131, s42, v131
    v_cvt_pk_bf16_f32 v24, v128, v129
    v_cvt_pk_bf16_f32 v25, v130, v131
    v_mul_f32 v132, s42, v132
    v_mul_f32 v133, s42, v133
    v_mul_f32 v134, s42, v134
    v_mul_f32 v135, s42, v135
    v_cvt_pk_bf16_f32 v26, v132, v133
    v_cvt_pk_bf16_f32 v27, v134, v135
    v_mul_f32 v136, s42, v136
    v_mul_f32 v137, s42, v137
    v_mul_f32 v138, s42, v138
    v_mul_f32 v139, s42, v139
    v_cvt_pk_bf16_f32 v28, v136, v137
    v_cvt_pk_bf16_f32 v29, v138, v139
    v_mul_f32 v140, s42, v140
    v_mul_f32 v141, s42, v141
    v_mul_f32 v142, s42, v142
    v_mul_f32 v143, s42, v143
    v_cvt_pk_bf16_f32 v30, v140, v141
    v_cvt_pk_bf16_f32 v31, v142, v143
    s_add_u32 s47, s44, 0
    buffer_store_dwordx2 v[24:25], v21, s[20:23], s47 offen
    s_add_u32 s47, s44, 16
    buffer_store_dwordx2 v[26:27], v21, s[20:23], s47 offen
    s_add_u32 s47, s44, 65536
    buffer_store_dwordx2 v[28:29], v21, s[20:23], s47 offen
    s_add_u32 s47, s44, 65552
    buffer_store_dwordx2 v[30:31], v21, s[20:23], s47 offen
    v_mul_f32 v144, s42, v144
    v_mul_f32 v145, s42, v145
    v_mul_f32 v146, s42, v146
    v_mul_f32 v147, s42, v147
    v_cvt_pk_bf16_f32 v24, v144, v145
    v_cvt_pk_bf16_f32 v25, v146, v147
    v_mul_f32 v148, s42, v148
    v_mul_f32 v149, s42, v149
    v_mul_f32 v150, s42, v150
    v_mul_f32 v151, s42, v151
    v_cvt_pk_bf16_f32 v26, v148, v149
    v_cvt_pk_bf16_f32 v27, v150, v151
    v_mul_f32 v152, s42, v152
    v_mul_f32 v153, s42, v153
    v_mul_f32 v154, s42, v154
    v_mul_f32 v155, s42, v155
    v_cvt_pk_bf16_f32 v28, v152, v153
    v_cvt_pk_bf16_f32 v29, v154, v155
    v_mul_f32 v156, s42, v156
    v_mul_f32 v157, s42, v157
    v_mul_f32 v158, s42, v158
    v_mul_f32 v159, s42, v159
    v_cvt_pk_bf16_f32 v30, v156, v157
    v_cvt_pk_bf16_f32 v31, v158, v159
    s_add_u32 s47, s44, 131072
    buffer_store_dwordx2 v[24:25], v21, s[20:23], s47 offen
    s_add_u32 s47, s44, 131088
    buffer_store_dwordx2 v[26:27], v21, s[20:23], s47 offen
    s_add_u32 s47, s44, 196608
    buffer_store_dwordx2 v[28:29], v21, s[20:23], s47 offen
    s_add_u32 s47, s44, 196624
    buffer_store_dwordx2 v[30:31], v21, s[20:23], s47 offen
    v_mul_f32 v160, s42, v160
    v_mul_f32 v161, s42, v161
    v_mul_f32 v162, s42, v162
    v_mul_f32 v163, s42, v163
    v_cvt_pk_bf16_f32 v24, v160, v161
    v_cvt_pk_bf16_f32 v25, v162, v163
    v_mul_f32 v164, s42, v164
    v_mul_f32 v165, s42, v165
    v_mul_f32 v166, s42, v166
    v_mul_f32 v167, s42, v167
    v_cvt_pk_bf16_f32 v26, v164, v165
    v_cvt_pk_bf16_f32 v27, v166, v167
    v_mul_f32 v168, s42, v168
    v_mul_f32 v169, s42, v169
    v_mul_f32 v170, s42, v170
    v_mul_f32 v171, s42, v171
    v_cvt_pk_bf16_f32 v28, v168, v169
    v_cvt_pk_bf16_f32 v29, v170, v171
    v_mul_f32 v172, s42, v172
    v_mul_f32 v173, s42, v173
    v_mul_f32 v174, s42, v174
    v_mul_f32 v175, s42, v175
    v_cvt_pk_bf16_f32 v30, v172, v173
    v_cvt_pk_bf16_f32 v31, v174, v175
    s_add_u32 s47, s44, 262144
    buffer_store_dwordx2 v[24:25], v21, s[20:23], s47 offen
    s_add_u32 s47, s44, 262160
    buffer_store_dwordx2 v[26:27], v21, s[20:23], s47 offen
    s_add_u32 s47, s44, 327680
    buffer_store_dwordx2 v[28:29], v21, s[20:23], s47 offen
    s_add_u32 s47, s44, 327696
    buffer_store_dwordx2 v[30:31], v21, s[20:23], s47 offen
    v_mul_f32 v176, s42, v176
    v_mul_f32 v177, s42, v177
    v_mul_f32 v178, s42, v178
    v_mul_f32 v179, s42, v179
    v_cvt_pk_bf16_f32 v24, v176, v177
    v_cvt_pk_bf16_f32 v25, v178, v179
    v_mul_f32 v180, s42, v180
    v_mul_f32 v181, s42, v181
    v_mul_f32 v182, s42, v182
    v_mul_f32 v183, s42, v183
    v_cvt_pk_bf16_f32 v26, v180, v181
    v_cvt_pk_bf16_f32 v27, v182, v183
    v_mul_f32 v184, s42, v184
    v_mul_f32 v185, s42, v185
    v_mul_f32 v186, s42, v186
    v_mul_f32 v187, s42, v187
    v_cvt_pk_bf16_f32 v28, v184, v185
    v_cvt_pk_bf16_f32 v29, v186, v187
    v_mul_f32 v188, s42, v188
    v_mul_f32 v189, s42, v189
    v_mul_f32 v190, s42, v190
    v_mul_f32 v191, s42, v191
    v_cvt_pk_bf16_f32 v30, v188, v189
    v_cvt_pk_bf16_f32 v31, v190, v191
    s_add_u32 s47, s44, 393216
    buffer_store_dwordx2 v[24:25], v21, s[20:23], s47 offen
    s_add_u32 s47, s44, 393232
    buffer_store_dwordx2 v[26:27], v21, s[20:23], s47 offen
    s_add_u32 s47, s44, 458752
    buffer_store_dwordx2 v[28:29], v21, s[20:23], s47 offen
    s_add_u32 s47, s44, 458768
    buffer_store_dwordx2 v[30:31], v21, s[20:23], s47 offen
    v_lshrrev_b32 v22, 4, v1
    v_and_b32 v22, 1, v22
    v_lshlrev_b32 v22, 16, v22
    v_lshl_add_u32 v22, v5, 8, v22
    v_and_b32 v23, 15, v1
    v_lshl_add_u32 v22, v23, 4, v22
    s_lshl_b32 s45, s24, 5
    s_lshl_b32 s46, s30, 2
    s_add_u32 s45, s45, s46
    s_lshl_b32 s45, s45, 6
    s_lshl_b32 s46, s29, 2
    s_add_u32 s46, s46, s31
    s_add_u32 s45, s45, s46
    s_lshl_b32 s45, s45, 10
    s_add_u32 s45, s45, 8388608
    v_cvt_pk_bf16_f32 v24, v192, v193
    v_cvt_pk_bf16_f32 v25, v194, v195
    v_cvt_pk_bf16_f32 v26, v196, v197
    v_cvt_pk_bf16_f32 v27, v198, v199
    s_add_u32 s47, s45, 0
    buffer_store_dwordx4 v[24:27], v22, s[20:23], s47 offen
    v_cvt_pk_bf16_f32 v28, v200, v201
    v_cvt_pk_bf16_f32 v29, v202, v203
    v_cvt_pk_bf16_f32 v30, v204, v205
    v_cvt_pk_bf16_f32 v31, v206, v207
    s_add_u32 s47, s45, 512
    buffer_store_dwordx4 v[28:31], v22, s[20:23], s47 offen
    v_cvt_pk_bf16_f32 v24, v208, v209
    v_cvt_pk_bf16_f32 v25, v210, v211
    v_cvt_pk_bf16_f32 v26, v212, v213
    v_cvt_pk_bf16_f32 v27, v214, v215
    s_add_u32 s47, s45, 131072
    buffer_store_dwordx4 v[24:27], v22, s[20:23], s47 offen
    v_cvt_pk_bf16_f32 v28, v216, v217
    v_cvt_pk_bf16_f32 v29, v218, v219
    v_cvt_pk_bf16_f32 v30, v220, v221
    v_cvt_pk_bf16_f32 v31, v222, v223
    s_add_u32 s47, s45, 131584
    buffer_store_dwordx4 v[28:31], v22, s[20:23], s47 offen
    s_waitcnt vmcnt(0)
    s_nop 0
L_k1_end:
    s_endpgm
.globl attn_kernel
.p2align 8
.type attn_kernel,@function
attn_kernel:
    s_cmp_ge_u32 s2, 1024
    s_cbranch_scc1 L_k2_end
    s_load_dwordx2 s[8:9], s[0:1], 64
    s_lshr_b32 s24, s2, 9
    s_and_b32 s25, s2, 511
    s_and_b32 s26, s25, 7
    s_lshl_b32 s26, s26, 2
    s_lshr_b32 s27, s25, 3
    s_and_b32 s27, s27, 3
    s_add_u32 s26, s26, s27
    s_lshr_b32 s27, s25, 5
    s_sub_u32 s28, 1, s24
    s_lshl_b32 s29, s28, 5
    s_add_u32 s29, s29, s26
    v_and_b32 v120, 63, v0
    v_lshrrev_b32 v121, 6, v0
    s_nop 0
    v_readfirstlane_b32 s30, v121
    s_waitcnt lgkmcnt(0)
    s_mov_b32 s20, s8
    s_and_b32 s21, s9, 0xffff
    s_mov_b32 s22, 16777216
    s_mov_b32 s23, 0x00020000
    v_and_b32 v122, 31, v120
    v_lshrrev_b32 v123, 5, v120
    s_lshl_b32 s31, s27, 7
    s_lshl_b32 s32, s30, 5
    s_add_u32 s31, s31, s32
    s_lshl_b32 s32, s29, 11
    s_add_u32 s32, s32, s31
    s_lshl_b32 s32, s32, 5
    v_lshlrev_b32 v124, 5, v122
    v_lshl_add_u32 v124, v123, 4, v124
    buffer_load_dwordx4 v[4:7], v124, s[20:23], s32 offen
    v_lshlrev_b32 v1, 5, v122
    v_lshl_add_u32 v1, v123, 4, v1
    v_and_b32 v125, 15, v120
    v_lshlrev_b32 v2, 4, v125
    v_lshl_add_u32 v2, v123, 8, v2
    v_lshlrev_b32 v125, 2, v123
    v_sub_u32 v3, v122, v125
    v_lshlrev_b32 v126, 4, v120
    v_mov_b32 v127, 0xff800000
    s_mov_b32 s50, 0xffff
    s_mov_b32 s51, 0xffff
    s_mov_b32 s52, 0x41800000
    v_mov_b32 v125, 0
    v_mov_b32 v121, 0x3f803f80
    v_cmp_eq_u32 vcc, 16, v122
    s_nop 1
    v_cndmask_b32 v125, v125, v121, vcc
    v_cmp_eq_u32 vcc, 20, v122
    s_nop 1
    v_cndmask_b32 v125, v125, v121, vcc
    v_mov_b32 v16, v125
    v_mov_b32 v17, v125
    v_mov_b32 v18, v125
    v_mov_b32 v19, v125
    v_mov_b32 v20, v125
    v_mov_b32 v21, v125
    v_mov_b32 v22, v125
    v_mov_b32 v23, v125
    v_mov_b32 v24, v125
    v_mov_b32 v25, v125
    v_mov_b32 v26, v125
    v_mov_b32 v27, v125
    v_mov_b32 v28, v125
    v_mov_b32 v29, v125
    v_mov_b32 v30, v125
    v_mov_b32 v31, v125
    v_mov_b32 v72, 0
    v_mov_b32 v88, 0
    v_mov_b32 v73, 0
    v_mov_b32 v89, 0
    v_mov_b32 v74, 0
    v_mov_b32 v90, 0
    v_mov_b32 v75, 0
    v_mov_b32 v91, 0
    v_mov_b32 v76, 0
    v_mov_b32 v92, 0
    v_mov_b32 v77, 0
    v_mov_b32 v93, 0
    v_mov_b32 v78, 0
    v_mov_b32 v94, 0
    v_mov_b32 v79, 0
    v_mov_b32 v95, 0
    v_mov_b32 v80, 0
    v_mov_b32 v96, 0
    v_mov_b32 v81, 0
    v_mov_b32 v97, 0
    v_mov_b32 v82, 0
    v_mov_b32 v98, 0
    v_mov_b32 v83, 0
    v_mov_b32 v99, 0
    v_mov_b32 v84, 0
    v_mov_b32 v100, 0
    v_mov_b32 v85, 0
    v_mov_b32 v101, 0
    v_mov_b32 v86, 0
    v_mov_b32 v102, 0
    v_mov_b32 v87, 0
    v_mov_b32 v103, 0
    s_lshl_b32 s58, s30, 10
    s_lshl_b32 s33, s29, 16
    s_add_u32 s33, s33, s58
    s_add_u32 s34, s33, 8388608
    s_add_u32 s33, s33, 4194304
    s_cmp_eq_u32 s24, 1
    s_cbranch_scc1 L_k2_A
    s_add_u32 s60, s58, 0
    s_mov_b32 m0, s60
    s_nop 0
    buffer_load_dwordx4 v126, s[20:23], s33 offen lds
    s_add_u32 s60, s58, 4096
    s_mov_b32 m0, s60
    s_nop 0
    buffer_load_dwordx4 v126, s[20:23], s34 offen lds
    s_add_u32 s33, s33, 4096
    s_add_u32 s34, s34, 4096
    s_waitcnt vmcnt(0)
    s_barrier
    s_mov_b32 s35, 0
    s_add_u32 s60, s58, 8192
    s_mov_b32 m0, s60
    s_nop 0
    buffer_load_dwordx4 v126, s[20:23], s33 offen lds
    s_add_u32 s60, s58, 12288
    s_mov_b32 m0, s60
    s_nop 0
    buffer_load_dwordx4 v126, s[20:23], s34 offen lds
    s_add_u32 s33, s33, 4096
    s_add_u32 s34, s34, 4096
    ds_read_b128 v[8:11], v1 offset:0
    s_mov_b64 exec, s[50:51]
    ds_read_b128 v[16:19], v2 offset:4096
    ds_read_b128 v[20:23], v2 offset:4608
    s_mov_b64 exec, -1
    s_waitcnt lgkmcnt(0)
    v_mfma_f32_32x32x16_bf16 v[32:47], v[8:11], v[4:7], v[72:87]
    ds_read_b128 v[12:15], v1 offset:1024
    s_mov_b64 exec, s[50:51]
    ds_read_b128 v[24:27], v2 offset:5120
    ds_read_b128 v[28:31], v2 offset:5632
    s_mov_b64 exec, -1
    s_nop 6
    v_max3_f32 v120, v32, v33, v34
    v_max3_f32 v120, v120, v35, v36
    v_max3_f32 v120, v120, v37, v38
    v_max3_f32 v120, v120, v39, v40
    v_max3_f32 v120, v120, v41, v42
    v_max3_f32 v120, v120, v43, v44
    v_max3_f32 v120, v120, v45, v46
    v_max_f32 v120, v120, v47
    v_mov_b32 v121, v120
    s_nop 1
    v_permlane32_swap_b32 v121, v120
    v_max_f32 v120, v120, v121
    v_sub_f32 v32, v32, v120
    v_sub_f32 v33, v33, v120
    v_sub_f32 v34, v34, v120
    v_sub_f32 v35, v35, v120
    v_sub_f32 v36, v36, v120
    v_sub_f32 v37, v37, v120
    v_sub_f32 v38, v38, v120
    v_sub_f32 v39, v39, v120
    v_sub_f32 v40, v40, v120
    v_sub_f32 v41, v41, v120
    v_sub_f32 v42, v42, v120
    v_sub_f32 v43, v43, v120
    v_sub_f32 v44, v44, v120
    v_sub_f32 v45, v45, v120
    v_sub_f32 v46, v46, v120
    v_sub_f32 v47, v47, v120
    v_sub_f32 v72, v72, v120
    v_sub_f32 v73, v73, v120
    v_sub_f32 v74, v74, v120
    v_sub_f32 v75, v75, v120
    v_sub_f32 v76, v76, v120
    v_sub_f32 v77, v77, v120
    v_sub_f32 v78, v78, v120
    v_sub_f32 v79, v79, v120
    v_sub_f32 v80, v80, v120
    v_sub_f32 v81, v81, v120
    v_sub_f32 v82, v82, v120
    v_sub_f32 v83, v83, v120
    v_sub_f32 v84, v84, v120
    v_sub_f32 v85, v85, v120
    v_sub_f32 v86, v86, v120
    v_sub_f32 v87, v87, v120
    s_waitcnt lgkmcnt(0)
    s_nop 0
    v_mfma_f32_32x32x16_bf16 v[48:63], v[12:15], v[4:7], v[72:87]
    v_exp_f32 v32, v32
    v_exp_f32 v33, v33
    v_exp_f32 v34, v34
    v_exp_f32 v35, v35
    v_exp_f32 v36, v36
    v_exp_f32 v37, v37
    v_exp_f32 v38, v38
    v_exp_f32 v39, v39
    v_exp_f32 v40, v40
    v_exp_f32 v41, v41
    v_exp_f32 v42, v42
    v_exp_f32 v43, v43
    v_exp_f32 v44, v44
    v_exp_f32 v45, v45
    v_exp_f32 v46, v46
    v_exp_f32 v47, v47
    v_cvt_pk_bf16_f32 v64, v32, v33
    v_cvt_pk_bf16_f32 v65, v34, v35
    v_cvt_pk_bf16_f32 v66, v36, v37
    v_cvt_pk_bf16_f32 v67, v38, v39
    v_cvt_pk_bf16_f32 v68, v40, v41
    v_cvt_pk_bf16_f32 v69, v42, v43
    v_cvt_pk_bf16_f32 v70, v44, v45
    v_cvt_pk_bf16_f32 v71, v46, v47
    v_mfma_f32_32x32x16_bf16 v[88:103], v[16:19], v[64:67], v[88:103]
    s_nop 0
    v_mfma_f32_32x32x16_bf16 v[88:103], v[20:23], v[68:71], v[88:103]
    ds_read_b128 v[8:11], v1 offset:2048
    s_mov_b64 exec, s[50:51]
    ds_read_b128 v[16:19], v2 offset:6144
    ds_read_b128 v[20:23], v2 offset:6656
    s_mov_b64 exec, -1
    v_max3_f32 v120, v48, v49, v50
    v_max3_f32 v120, v120, v51, v52
    v_max3_f32 v120, v120, v53, v54
    v_max3_f32 v120, v120, v55, v56
    v_max3_f32 v120, v120, v57, v58
    v_max3_f32 v120, v120, v59, v60
    v_max3_f32 v120, v120, v61, v62
    v_max_f32 v120, v120, v63
    v_cmp_lt_f32 vcc, s52, v120
    s_cbranch_vccnz L_rare_0
    s_nop 3
L_back_0:
    s_waitcnt lgkmcnt(0)
    v_mfma_f32_32x32x16_bf16 v[32:47], v[8:11], v[4:7], v[72:87]
    v_exp_f32 v48, v48
    v_exp_f32 v49, v49
    v_exp_f32 v50, v50
    v_exp_f32 v51, v51
    v_exp_f32 v52, v52
    v_exp_f32 v53, v53
    v_exp_f32 v54, v54
    v_exp_f32 v55, v55
    v_exp_f32 v56, v56
    v_exp_f32 v57, v57
    v_exp_f32 v58, v58
    v_exp_f32 v59, v59
    v_exp_f32 v60, v60
    v_exp_f32 v61, v61
    v_exp_f32 v62, v62
    v_exp_f32 v63, v63
    v_cvt_pk_bf16_f32 v64, v48, v49
    v_cvt_pk_bf16_f32 v65, v50, v51
    v_cvt_pk_bf16_f32 v66, v52, v53
    v_cvt_pk_bf16_f32 v67, v54, v55
    v_cvt_pk_bf16_f32 v68, v56, v57
    v_cvt_pk_bf16_f32 v69, v58, v59
    v_cvt_pk_bf16_f32 v70, v60, v61
    v_cvt_pk_bf16_f32 v71, v62, v63
    v_mfma_f32_32x32x16_bf16 v[88:103], v[24:27], v[64:67], v[88:103]
    s_nop 0
    v_mfma_f32_32x32x16_bf16 v[88:103], v[28:31], v[68:71], v[88:103]
    ds_read_b128 v[12:15], v1 offset:3072
    s_mov_b64 exec, s[50:51]
    ds_read_b128 v[24:27], v2 offset:7168
    ds_read_b128 v[28:31], v2 offset:7680
    s_mov_b64 exec, -1
    v_max3_f32 v120, v32, v33, v34
    v_max3_f32 v120, v120, v35, v36
    v_max3_f32 v120, v120, v37, v38
    v_max3_f32 v120, v120, v39, v40
    v_max3_f32 v120, v120, v41, v42
    v_max3_f32 v120, v120, v43, v44
    v_max3_f32 v120, v120, v45, v46
    v_max_f32 v120, v120, v47
    v_cmp_lt_f32 vcc, s52, v120
    s_cbranch_vccnz L_rare_1
    s_nop 3
L_back_1:
    s_waitcnt lgkmcnt(0)
    v_mfma_f32_32x32x16_bf16 v[48:63], v[12:15], v[4:7], v[72:87]
    v_exp_f32 v32, v32
    v_exp_f32 v33, v33
    v_exp_f32 v34, v34
    v_exp_f32 v35, v35
    v_exp_f32 v36, v36
    v_exp_f32 v37, v37
    v_exp_f32 v38, v38
    v_exp_f32 v39, v39
    v_exp_f32 v40, v40
    v_exp_f32 v41, v41
    v_exp_f32 v42, v42
    v_exp_f32 v43, v43
    v_exp_f32 v44, v44
    v_exp_f32 v45, v45
    v_exp_f32 v46, v46
    v_exp_f32 v47, v47
    v_cvt_pk_bf16_f32 v64, v32, v33
    v_cvt_pk_bf16_f32 v65, v34, v35
    v_cvt_pk_bf16_f32 v66, v36, v37
    v_cvt_pk_bf16_f32 v67, v38, v39
    v_cvt_pk_bf16_f32 v68, v40, v41
    v_cvt_pk_bf16_f32 v69, v42, v43
    v_cvt_pk_bf16_f32 v70, v44, v45
    v_cvt_pk_bf16_f32 v71, v46, v47
    v_mfma_f32_32x32x16_bf16 v[88:103], v[16:19], v[64:67], v[88:103]
    s_nop 0
    v_mfma_f32_32x32x16_bf16 v[88:103], v[20:23], v[68:71], v[88:103]
    v_max3_f32 v120, v48, v49, v50
    v_max3_f32 v120, v120, v51, v52
    v_max3_f32 v120, v120, v53, v54
    v_max3_f32 v120, v120, v55, v56
    v_max3_f32 v120, v120, v57, v58
    v_max3_f32 v120, v120, v59, v60
    v_max3_f32 v120, v120, v61, v62
    v_max_f32 v120, v120, v63
    v_cmp_lt_f32 vcc, s52, v120
    s_cbranch_vccnz L_rare_2
    s_nop 3
L_back_2:
    v_exp_f32 v48, v48
    v_exp_f32 v49, v49
    v_exp_f32 v50, v50
    v_exp_f32 v51, v51
    v_exp_f32 v52, v52
    v_exp_f32 v53, v53
    v_exp_f32 v54, v54
    v_exp_f32 v55, v55
    v_exp_f32 v56, v56
    v_exp_f32 v57, v57
    v_exp_f32 v58, v58
    v_exp_f32 v59, v59
    v_exp_f32 v60, v60
    v_exp_f32 v61, v61
    v_exp_f32 v62, v62
    v_exp_f32 v63, v63
    v_cvt_pk_bf16_f32 v64, v48, v49
    v_cvt_pk_bf16_f32 v65, v50, v51
    v_cvt_pk_bf16_f32 v66, v52, v53
    v_cvt_pk_bf16_f32 v67, v54, v55
    v_cvt_pk_bf16_f32 v68, v56, v57
    v_cvt_pk_bf16_f32 v69, v58, v59
    v_cvt_pk_bf16_f32 v70, v60, v61
    v_cvt_pk_bf16_f32 v71, v62, v63
    v_mfma_f32_32x32x16_bf16 v[88:103], v[24:27], v[64:67], v[88:103]
    s_nop 0
    v_mfma_f32_32x32x16_bf16 v[88:103], v[28:31], v[68:71], v[88:103]
    s_waitcnt vmcnt(0)
    s_barrier
    s_add_u32 s60, s58, 0
    s_mov_b32 m0, s60
    s_nop 0
    buffer_load_dwordx4 v126, s[20:23], s33 offen lds
    s_add_u32 s60, s58, 4096
    s_mov_b32 m0, s60
    s_nop 0
    buffer_load_dwordx4 v126, s[20:23], s34 offen lds
    s_add_u32 s33, s33, 4096
    s_add_u32 s34, s34, 4096
    ds_read_b128 v[8:11], v1 offset:8192
    s_mov_b64 exec, s[50:51]
    ds_read_b128 v[16:19], v2 offset:12288
    ds_read_b128 v[20:23], v2 offset:12800
    s_mov_b64 exec, -1
    s_waitcnt lgkmcnt(0)
    v_mfma_f32_32x32x16_bf16 v[32:47], v[8:11], v[4:7], v[72:87]
    ds_read_b128 v[12:15], v1 offset:9216
    s_mov_b64 exec, s[50:51]
    ds_read_b128 v[24:27], v2 offset:13312
    ds_read_b128 v[28:31], v2 offset:13824
    s_mov_b64 exec, -1
    s_nop 6
    v_max3_f32 v120, v32, v33, v34
    v_max3_f32 v120, v120, v35, v36
    v_max3_f32 v120, v120, v37, v38
    v_max3_f32 v120, v120, v39, v40
    v_max3_f32 v120, v120, v41, v42
    v_max3_f32 v120, v120, v43, v44
    v_max3_f32 v120, v120, v45, v46
    v_max_f32 v120, v120, v47
    v_cmp_lt_f32 vcc, s52, v120
    s_cbranch_vccnz L_rare_3
    s_nop 3
L_back_3:
    s_waitcnt lgkmcnt(0)
    v_mfma_f32_32x32x16_bf16 v[48:63], v[12:15], v[4:7], v[72:87]
    v_exp_f32 v32, v32
    v_exp_f32 v33, v33
    v_exp_f32 v34, v34
    v_exp_f32 v35, v35
    v_exp_f32 v36, v36
    v_exp_f32 v37, v37
    v_exp_f32 v38, v38
    v_exp_f32 v39, v39
    v_exp_f32 v40, v40
    v_exp_f32 v41, v41
    v_exp_f32 v42, v42
    v_exp_f32 v43, v43
    v_exp_f32 v44, v44
    v_exp_f32 v45, v45
    v_exp_f32 v46, v46
    v_exp_f32 v47, v47
    v_cvt_pk_bf16_f32 v64, v32, v33
    v_cvt_pk_bf16_f32 v65, v34, v35
    v_cvt_pk_bf16_f32 v66, v36, v37
    v_cvt_pk_bf16_f32 v67, v38, v39
    v_cvt_pk_bf16_f32 v68, v40, v41
    v_cvt_pk_bf16_f32 v69, v42, v43
    v_cvt_pk_bf16_f32 v70, v44, v45
    v_cvt_pk_bf16_f32 v71, v46, v47
    v_mfma_f32_32x32x16_bf16 v[88:103], v[16:19], v[64:67], v[88:103]
    s_nop 0
    v_mfma_f32_32x32x16_bf16 v[88:103], v[20:23], v[68:71], v[88:103]
    ds_read_b128 v[8:11], v1 offset:10240
    s_mov_b64 exec, s[50:51]
    ds_read_b128 v[16:19], v2 offset:14336
    ds_read_b128 v[20:23], v2 offset:14848
    s_mov_b64 exec, -1
    v_max3_f32 v120, v48, v49, v50
    v_max3_f32 v120, v120, v51, v52
    v_max3_f32 v120, v120, v53, v54
    v_max3_f32 v120, v120, v55, v56
    v_max3_f32 v120, v120, v57, v58
    v_max3_f32 v120, v120, v59, v60
    v_max3_f32 v120, v120, v61, v62
    v_max_f32 v120, v120, v63
    v_cmp_lt_f32 vcc, s52, v120
    s_cbranch_vccnz L_rare_4
    s_nop 3
L_back_4:
    s_waitcnt lgkmcnt(0)
    v_mfma_f32_32x32x16_bf16 v[32:47], v[8:11], v[4:7], v[72:87]
    v_exp_f32 v48, v48
    v_exp_f32 v49, v49
    v_exp_f32 v50, v50
    v_exp_f32 v51, v51
    v_exp_f32 v52, v52
    v_exp_f32 v53, v53
    v_exp_f32 v54, v54
    v_exp_f32 v55, v55
    v_exp_f32 v56, v56
    v_exp_f32 v57, v57
    v_exp_f32 v58, v58
    v_exp_f32 v59, v59
    v_exp_f32 v60, v60
    v_exp_f32 v61, v61
    v_exp_f32 v62, v62
    v_exp_f32 v63, v63
    v_cvt_pk_bf16_f32 v64, v48, v49
    v_cvt_pk_bf16_f32 v65, v50, v51
    v_cvt_pk_bf16_f32 v66, v52, v53
    v_cvt_pk_bf16_f32 v67, v54, v55
    v_cvt_pk_bf16_f32 v68, v56, v57
    v_cvt_pk_bf16_f32 v69, v58, v59
    v_cvt_pk_bf16_f32 v70, v60, v61
    v_cvt_pk_bf16_f32 v71, v62, v63
    v_mfma_f32_32x32x16_bf16 v[88:103], v[24:27], v[64:67], v[88:103]
    s_nop 0
    v_mfma_f32_32x32x16_bf16 v[88:103], v[28:31], v[68:71], v[88:103]
    ds_read_b128 v[12:15], v1 offset:11264
    s_mov_b64 exec, s[50:51]
    ds_read_b128 v[24:27], v2 offset:15360
    ds_read_b128 v[28:31], v2 offset:15872
    s_mov_b64 exec, -1
    v_max3_f32 v120, v32, v33, v34
    v_max3_f32 v120, v120, v35, v36
    v_max3_f32 v120, v120, v37, v38
    v_max3_f32 v120, v120, v39, v40
    v_max3_f32 v120, v120, v41, v42
    v_max3_f32 v120, v120, v43, v44
    v_max3_f32 v120, v120, v45, v46
    v_max_f32 v120, v120, v47
    v_cmp_lt_f32 vcc, s52, v120
    s_cbranch_vccnz L_rare_5
    s_nop 3
L_back_5:
    s_waitcnt lgkmcnt(0)
    v_mfma_f32_32x32x16_bf16 v[48:63], v[12:15], v[4:7], v[72:87]
    v_exp_f32 v32, v32
    v_exp_f32 v33, v33
    v_exp_f32 v34, v34
    v_exp_f32 v35, v35
    v_exp_f32 v36, v36
    v_exp_f32 v37, v37
    v_exp_f32 v38, v38
    v_exp_f32 v39, v39
    v_exp_f32 v40, v40
    v_exp_f32 v41, v41
    v_exp_f32 v42, v42
    v_exp_f32 v43, v43
    v_exp_f32 v44, v44
    v_exp_f32 v45, v45
    v_exp_f32 v46, v46
    v_exp_f32 v47, v47
    v_cvt_pk_bf16_f32 v64, v32, v33
    v_cvt_pk_bf16_f32 v65, v34, v35
    v_cvt_pk_bf16_f32 v66, v36, v37
    v_cvt_pk_bf16_f32 v67, v38, v39
    v_cvt_pk_bf16_f32 v68, v40, v41
    v_cvt_pk_bf16_f32 v69, v42, v43
    v_cvt_pk_bf16_f32 v70, v44, v45
    v_cvt_pk_bf16_f32 v71, v46, v47
    v_mfma_f32_32x32x16_bf16 v[88:103], v[16:19], v[64:67], v[88:103]
    s_nop 0
    v_mfma_f32_32x32x16_bf16 v[88:103], v[20:23], v[68:71], v[88:103]
    v_max3_f32 v120, v48, v49, v50
    v_max3_f32 v120, v120, v51, v52
    v_max3_f32 v120, v120, v53, v54
    v_max3_f32 v120, v120, v55, v56
    v_max3_f32 v120, v120, v57, v58
    v_max3_f32 v120, v120, v59, v60
    v_max3_f32 v120, v120, v61, v62
    v_max_f32 v120, v120, v63
    v_cmp_lt_f32 vcc, s52, v120
    s_cbranch_vccnz L_rare_6
    s_nop 3
L_back_6:
    v_exp_f32 v48, v48
    v_exp_f32 v49, v49
    v_exp_f32 v50, v50
    v_exp_f32 v51, v51
    v_exp_f32 v52, v52
    v_exp_f32 v53, v53
    v_exp_f32 v54, v54
    v_exp_f32 v55, v55
    v_exp_f32 v56, v56
    v_exp_f32 v57, v57
    v_exp_f32 v58, v58
    v_exp_f32 v59, v59
    v_exp_f32 v60, v60
    v_exp_f32 v61, v61
    v_exp_f32 v62, v62
    v_exp_f32 v63, v63
    v_cvt_pk_bf16_f32 v64, v48, v49
    v_cvt_pk_bf16_f32 v65, v50, v51
    v_cvt_pk_bf16_f32 v66, v52, v53
    v_cvt_pk_bf16_f32 v67, v54, v55
    v_cvt_pk_bf16_f32 v68, v56, v57
    v_cvt_pk_bf16_f32 v69, v58, v59
    v_cvt_pk_bf16_f32 v70, v60, v61
    v_cvt_pk_bf16_f32 v71, v62, v63
    v_mfma_f32_32x32x16_bf16 v[88:103], v[24:27], v[64:67], v[88:103]
    s_nop 0
    v_mfma_f32_32x32x16_bf16 v[88:103], v[28:31], v[68:71], v[88:103]
    s_waitcnt vmcnt(0)
    s_barrier
    s_nop 9
L_B_loop:
    s_add_u32 s60, s58, 8192
    s_mov_b32 m0, s60
    s_nop 0
    buffer_load_dwordx4 v126, s[20:23], s33 offen lds
    s_add_u32 s60, s58, 12288
    s_mov_b32 m0, s60
    s_nop 0
    buffer_load_dwordx4 v126, s[20:23], s34 offen lds
    s_add_u32 s33, s33, 4096
    s_add_u32 s34, s34, 4096
    ds_read_b128 v[8:11], v1 offset:0
    s_mov_b64 exec, s[50:51]
    ds_read_b128 v[16:19], v2 offset:4096
    ds_read_b128 v[20:23], v2 offset:4608
    s_mov_b64 exec, -1
    s_waitcnt lgkmcnt(0)
    v_mfma_f32_32x32x16_bf16 v[32:47], v[8:11], v[4:7], v[72:87]
    ds_read_b128 v[12:15], v1 offset:1024
    s_mov_b64 exec, s[50:51]
    ds_read_b128 v[24:27], v2 offset:5120
    ds_read_b128 v[28:31], v2 offset:5632
    s_mov_b64 exec, -1
    s_nop 6
    v_max3_f32 v120, v32, v33, v34
    v_max3_f32 v120, v120, v35, v36
    v_max3_f32 v120, v120, v37, v38
    v_max3_f32 v120, v120, v39, v40
    v_max3_f32 v120, v120, v41, v42
    v_max3_f32 v120, v120, v43, v44
    v_max3_f32 v120, v120, v45, v46
    v_max_f32 v120, v120, v47
    v_cmp_lt_f32 vcc, s52, v120
    s_cbranch_vccnz L_rare_7
    s_nop 3
L_back_7:
    s_waitcnt lgkmcnt(0)
    v_mfma_f32_32x32x16_bf16 v[48:63], v[12:15], v[4:7], v[72:87]
    v_exp_f32 v32, v32
    v_exp_f32 v33, v33
    v_exp_f32 v34, v34
    v_exp_f32 v35, v35
    v_exp_f32 v36, v36
    v_exp_f32 v37, v37
    v_exp_f32 v38, v38
    v_exp_f32 v39, v39
    v_exp_f32 v40, v40
    v_exp_f32 v41, v41
    v_exp_f32 v42, v42
    v_exp_f32 v43, v43
    v_exp_f32 v44, v44
    v_exp_f32 v45, v45
    v_exp_f32 v46, v46
    v_exp_f32 v47, v47
    v_cvt_pk_bf16_f32 v64, v32, v33
    v_cvt_pk_bf16_f32 v65, v34, v35
    v_cvt_pk_bf16_f32 v66, v36, v37
    v_cvt_pk_bf16_f32 v67, v38, v39
    v_cvt_pk_bf16_f32 v68, v40, v41
    v_cvt_pk_bf16_f32 v69, v42, v43
    v_cvt_pk_bf16_f32 v70, v44, v45
    v_cvt_pk_bf16_f32 v71, v46, v47
    v_mfma_f32_32x32x16_bf16 v[88:103], v[16:19], v[64:67], v[88:103]
    s_nop 0
    v_mfma_f32_32x32x16_bf16 v[88:103], v[20:23], v[68:71], v[88:103]
    ds_read_b128 v[8:11], v1 offset:2048
    s_mov_b64 exec, s[50:51]
    ds_read_b128 v[16:19], v2 offset:6144
    ds_read_b128 v[20:23], v2 offset:6656
    s_mov_b64 exec, -1
    v_max3_f32 v120, v48, v49, v50
    v_max3_f32 v120, v120, v51, v52
    v_max3_f32 v120, v120, v53, v54
    v_max3_f32 v120, v120, v55, v56
    v_max3_f32 v120, v120, v57, v58
    v_max3_f32 v120, v120, v59, v60
    v_max3_f32 v120, v120, v61, v62
    v_max_f32 v120, v120, v63
    v_cmp_lt_f32 vcc, s52, v120
    s_cbranch_vccnz L_rare_8
    s_nop 3
L_back_8:
    s_waitcnt lgkmcnt(0)
    v_mfma_f32_32x32x16_bf16 v[32:47], v[8:11], v[4:7], v[72:87]
    v_exp_f32 v48, v48
    v_exp_f32 v49, v49
    v_exp_f32 v50, v50
    v_exp_f32 v51, v51
    v_exp_f32 v52, v52
    v_exp_f32 v53, v53
    v_exp_f32 v54, v54
    v_exp_f32 v55, v55
    v_exp_f32 v56, v56
    v_exp_f32 v57, v57
    v_exp_f32 v58, v58
    v_exp_f32 v59, v59
    v_exp_f32 v60, v60
    v_exp_f32 v61, v61
    v_exp_f32 v62, v62
    v_exp_f32 v63, v63
    v_cvt_pk_bf16_f32 v64, v48, v49
    v_cvt_pk_bf16_f32 v65, v50, v51
    v_cvt_pk_bf16_f32 v66, v52, v53
    v_cvt_pk_bf16_f32 v67, v54, v55
    v_cvt_pk_bf16_f32 v68, v56, v57
    v_cvt_pk_bf16_f32 v69, v58, v59
    v_cvt_pk_bf16_f32 v70, v60, v61
    v_cvt_pk_bf16_f32 v71, v62, v63
    v_mfma_f32_32x32x16_bf16 v[88:103], v[24:27], v[64:67], v[88:103]
    s_nop 0
    v_mfma_f32_32x32x16_bf16 v[88:103], v[28:31], v[68:71], v[88:103]
    ds_read_b128 v[12:15], v1 offset:3072
    s_mov_b64 exec, s[50:51]
    ds_read_b128 v[24:27], v2 offset:7168
    ds_read_b128 v[28:31], v2 offset:7680
    s_mov_b64 exec, -1
    v_max3_f32 v120, v32, v33, v34
    v_max3_f32 v120, v120, v35, v36
    v_max3_f32 v120, v120, v37, v38
    v_max3_f32 v120, v120, v39, v40
    v_max3_f32 v120, v120, v41, v42
    v_max3_f32 v120, v120, v43, v44
    v_max3_f32 v120, v120, v45, v46
    v_max_f32 v120, v120, v47
    v_cmp_lt_f32 vcc, s52, v120
    s_cbranch_vccnz L_rare_9
    s_nop 3
L_back_9:
    s_waitcnt lgkmcnt(0)
    v_mfma_f32_32x32x16_bf16 v[48:63], v[12:15], v[4:7], v[72:87]
    v_exp_f32 v32, v32
    v_exp_f32 v33, v33
    v_exp_f32 v34, v34
    v_exp_f32 v35, v35
    v_exp_f32 v36, v36
    v_exp_f32 v37, v37
    v_exp_f32 v38, v38
    v_exp_f32 v39, v39
    v_exp_f32 v40, v40
    v_exp_f32 v41, v41
    v_exp_f32 v42, v42
    v_exp_f32 v43, v43
    v_exp_f32 v44, v44
    v_exp_f32 v45, v45
    v_exp_f32 v46, v46
    v_exp_f32 v47, v47
    v_cvt_pk_bf16_f32 v64, v32, v33
    v_cvt_pk_bf16_f32 v65, v34, v35
    v_cvt_pk_bf16_f32 v66, v36, v37
    v_cvt_pk_bf16_f32 v67, v38, v39
    v_cvt_pk_bf16_f32 v68, v40, v41
    v_cvt_pk_bf16_f32 v69, v42, v43
    v_cvt_pk_bf16_f32 v70, v44, v45
    v_cvt_pk_bf16_f32 v71, v46, v47
    v_mfma_f32_32x32x16_bf16 v[88:103], v[16:19], v[64:67], v[88:103]
    s_nop 0
    v_mfma_f32_32x32x16_bf16 v[88:103], v[20:23], v[68:71], v[88:103]
    v_max3_f32 v120, v48, v49, v50
    v_max3_f32 v120, v120, v51, v52
    v_max3_f32 v120, v120, v53, v54
    v_max3_f32 v120, v120, v55, v56
    v_max3_f32 v120, v120, v57, v58
    v_max3_f32 v120, v120, v59, v60
    v_max3_f32 v120, v120, v61, v62
    v_max_f32 v120, v120, v63
    v_cmp_lt_f32 vcc, s52, v120
    s_cbranch_vccnz L_rare_10
    s_nop 3
L_back_10:
    v_exp_f32 v48, v48
    v_exp_f32 v49, v49
    v_exp_f32 v50, v50
    v_exp_f32 v51, v51
    v_exp_f32 v52, v52
    v_exp_f32 v53, v53
    v_exp_f32 v54, v54
    v_exp_f32 v55, v55
    v_exp_f32 v56, v56
    v_exp_f32 v57, v57
    v_exp_f32 v58, v58
    v_exp_f32 v59, v59
    v_exp_f32 v60, v60
    v_exp_f32 v61, v61
    v_exp_f32 v62, v62
    v_exp_f32 v63, v63
    v_cvt_pk_bf16_f32 v64, v48, v49
    v_cvt_pk_bf16_f32 v65, v50, v51
    v_cvt_pk_bf16_f32 v66, v52, v53
    v_cvt_pk_bf16_f32 v67, v54, v55
    v_cvt_pk_bf16_f32 v68, v56, v57
    v_cvt_pk_bf16_f32 v69, v58, v59
    v_cvt_pk_bf16_f32 v70, v60, v61
    v_cvt_pk_bf16_f32 v71, v62, v63
    v_mfma_f32_32x32x16_bf16 v[88:103], v[24:27], v[64:67], v[88:103]
    s_nop 0
    v_mfma_f32_32x32x16_bf16 v[88:103], v[28:31], v[68:71], v[88:103]
    s_waitcnt vmcnt(0)
    s_barrier
    s_cmp_eq_u32 s35, 6
    s_cbranch_scc1 L_B_skipdma
    s_add_u32 s60, s58, 0
    s_mov_b32 m0, s60
    s_nop 0
    buffer_load_dwordx4 v126, s[20:23], s33 offen lds
    s_add_u32 s60, s58, 4096
    s_mov_b32 m0, s60
    s_nop 0
    buffer_load_dwordx4 v126, s[20:23], s34 offen lds
    s_add_u32 s33, s33, 4096
    s_add_u32 s34, s34, 4096
L_B_skipdma:
    ds_read_b128 v[8:11], v1 offset:8192
    s_mov_b64 exec, s[50:51]
    ds_read_b128 v[16:19], v2 offset:12288
    ds_read_b128 v[20:23], v2 offset:12800
    s_mov_b64 exec, -1
    s_waitcnt lgkmcnt(0)
    v_mfma_f32_32x32x16_bf16 v[32:47], v[8:11], v[4:7], v[72:87]
    ds_read_b128 v[12:15], v1 offset:9216
    s_mov_b64 exec, s[50:51]
    ds_read_b128 v[24:27], v2 offset:13312
    ds_read_b128 v[28:31], v2 offset:13824
    s_mov_b64 exec, -1
    s_nop 6
    v_max3_f32 v120, v32, v33, v34
    v_max3_f32 v120, v120, v35, v36
    v_max3_f32 v120, v120, v37, v38
    v_max3_f32 v120, v120, v39, v40
    v_max3_f32 v120, v120, v41, v42
    v_max3_f32 v120, v120, v43, v44
    v_max3_f32 v120, v120, v45, v46
    v_max_f32 v120, v120, v47
    v_cmp_lt_f32 vcc, s52, v120
    s_cbranch_vccnz L_rare_11
    s_nop 3
L_back_11:
    s_waitcnt lgkmcnt(0)
    v_mfma_f32_32x32x16_bf16 v[48:63], v[12:15], v[4:7], v[72:87]
    v_exp_f32 v32, v32
    v_exp_f32 v33, v33
    v_exp_f32 v34, v34
    v_exp_f32 v35, v35
    v_exp_f32 v36, v36
    v_exp_f32 v37, v37
    v_exp_f32 v38, v38
    v_exp_f32 v39, v39
    v_exp_f32 v40, v40
    v_exp_f32 v41, v41
    v_exp_f32 v42, v42
    v_exp_f32 v43, v43
    v_exp_f32 v44, v44
    v_exp_f32 v45, v45
    v_exp_f32 v46, v46
    v_exp_f32 v47, v47
    v_cvt_pk_bf16_f32 v64, v32, v33
    v_cvt_pk_bf16_f32 v65, v34, v35
    v_cvt_pk_bf16_f32 v66, v36, v37
    v_cvt_pk_bf16_f32 v67, v38, v39
    v_cvt_pk_bf16_f32 v68, v40, v41
    v_cvt_pk_bf16_f32 v69, v42, v43
    v_cvt_pk_bf16_f32 v70, v44, v45
    v_cvt_pk_bf16_f32 v71, v46, v47
    v_mfma_f32_32x32x16_bf16 v[88:103], v[16:19], v[64:67], v[88:103]
    s_nop 0
    v_mfma_f32_32x32x16_bf16 v[88:103], v[20:23], v[68:71], v[88:103]
    ds_read_b128 v[8:11], v1 offset:10240
    s_mov_b64 exec, s[50:51]
    ds_read_b128 v[16:19], v2 offset:14336
    ds_read_b128 v[20:23], v2 offset:14848
    s_mov_b64 exec, -1
    v_max3_f32 v120, v48, v49, v50
    v_max3_f32 v120, v120, v51, v52
    v_max3_f32 v120, v120, v53, v54
    v_max3_f32 v120, v120, v55, v56
    v_max3_f32 v120, v120, v57, v58
    v_max3_f32 v120, v120, v59, v60
    v_max3_f32 v120, v120, v61, v62
    v_max_f32 v120, v120, v63
    v_cmp_lt_f32 vcc, s52, v120
    s_cbranch_vccnz L_rare_12
    s_nop 3
L_back_12:
    s_waitcnt lgkmcnt(0)
    v_mfma_f32_32x32x16_bf16 v[32:47], v[8:11], v[4:7], v[72:87]
    v_exp_f32 v48, v48
    v_exp_f32 v49, v49
    v_exp_f32 v50, v50
    v_exp_f32 v51, v51
    v_exp_f32 v52, v52
    v_exp_f32 v53, v53
    v_exp_f32 v54, v54
    v_exp_f32 v55, v55
    v_exp_f32 v56, v56
    v_exp_f32 v57, v57
    v_exp_f32 v58, v58
    v_exp_f32 v59, v59
    v_exp_f32 v60, v60
    v_exp_f32 v61, v61
    v_exp_f32 v62, v62
    v_exp_f32 v63, v63
    v_cvt_pk_bf16_f32 v64, v48, v49
    v_cvt_pk_bf16_f32 v65, v50, v51
    v_cvt_pk_bf16_f32 v66, v52, v53
    v_cvt_pk_bf16_f32 v67, v54, v55
    v_cvt_pk_bf16_f32 v68, v56, v57
    v_cvt_pk_bf16_f32 v69, v58, v59
    v_cvt_pk_bf16_f32 v70, v60, v61
    v_cvt_pk_bf16_f32 v71, v62, v63
    v_mfma_f32_32x32x16_bf16 v[88:103], v[24:27], v[64:67], v[88:103]
    s_nop 0
    v_mfma_f32_32x32x16_bf16 v[88:103], v[28:31], v[68:71], v[88:103]
    ds_read_b128 v[12:15], v1 offset:11264
    s_mov_b64 exec, s[50:51]
    ds_read_b128 v[24:27], v2 offset:15360
    ds_read_b128 v[28:31], v2 offset:15872
    s_mov_b64 exec, -1
    v_max3_f32 v120, v32, v33, v34
    v_max3_f32 v120, v120, v35, v36
    v_max3_f32 v120, v120, v37, v38
    v_max3_f32 v120, v120, v39, v40
    v_max3_f32 v120, v120, v41, v42
    v_max3_f32 v120, v120, v43, v44
    v_max3_f32 v120, v120, v45, v46
    v_max_f32 v120, v120, v47
    v_cmp_lt_f32 vcc, s52, v120
    s_cbranch_vccnz L_rare_13
    s_nop 3
L_back_13:
    s_waitcnt lgkmcnt(0)
    v_mfma_f32_32x32x16_bf16 v[48:63], v[12:15], v[4:7], v[72:87]
    v_exp_f32 v32, v32
    v_exp_f32 v33, v33
    v_exp_f32 v34, v34
    v_exp_f32 v35, v35
    v_exp_f32 v36, v36
    v_exp_f32 v37, v37
    v_exp_f32 v38, v38
    v_exp_f32 v39, v39
    v_exp_f32 v40, v40
    v_exp_f32 v41, v41
    v_exp_f32 v42, v42
    v_exp_f32 v43, v43
    v_exp_f32 v44, v44
    v_exp_f32 v45, v45
    v_exp_f32 v46, v46
    v_exp_f32 v47, v47
    v_cvt_pk_bf16_f32 v64, v32, v33
    v_cvt_pk_bf16_f32 v65, v34, v35
    v_cvt_pk_bf16_f32 v66, v36, v37
    v_cvt_pk_bf16_f32 v67, v38, v39
    v_cvt_pk_bf16_f32 v68, v40, v41
    v_cvt_pk_bf16_f32 v69, v42, v43
    v_cvt_pk_bf16_f32 v70, v44, v45
    v_cvt_pk_bf16_f32 v71, v46, v47
    v_mfma_f32_32x32x16_bf16 v[88:103], v[16:19], v[64:67], v[88:103]
    s_nop 0
    v_mfma_f32_32x32x16_bf16 v[88:103], v[20:23], v[68:71], v[88:103]
    v_max3_f32 v120, v48, v49, v50
    v_max3_f32 v120, v120, v51, v52
    v_max3_f32 v120, v120, v53, v54
    v_max3_f32 v120, v120, v55, v56
    v_max3_f32 v120, v120, v57, v58
    v_max3_f32 v120, v120, v59, v60
    v_max3_f32 v120, v120, v61, v62
    v_max_f32 v120, v120, v63
    v_cmp_lt_f32 vcc, s52, v120
    s_cbranch_vccnz L_rare_14
    s_nop 3
L_back_14:
    v_exp_f32 v48, v48
    v_exp_f32 v49, v49
    v_exp_f32 v50, v50
    v_exp_f32 v51, v51
    v_exp_f32 v52, v52
    v_exp_f32 v53, v53
    v_exp_f32 v54, v54
    v_exp_f32 v55, v55
    v_exp_f32 v56, v56
    v_exp_f32 v57, v57
    v_exp_f32 v58, v58
    v_exp_f32 v59, v59
    v_exp_f32 v60, v60
    v_exp_f32 v61, v61
    v_exp_f32 v62, v62
    v_exp_f32 v63, v63
    v_cvt_pk_bf16_f32 v64, v48, v49
    v_cvt_pk_bf16_f32 v65, v50, v51
    v_cvt_pk_bf16_f32 v66, v52, v53
    v_cvt_pk_bf16_f32 v67, v54, v55
    v_cvt_pk_bf16_f32 v68, v56, v57
    v_cvt_pk_bf16_f32 v69, v58, v59
    v_cvt_pk_bf16_f32 v70, v60, v61
    v_cvt_pk_bf16_f32 v71, v62, v63
    v_mfma_f32_32x32x16_bf16 v[88:103], v[24:27], v[64:67], v[88:103]
    s_nop 0
    v_mfma_f32_32x32x16_bf16 v[88:103], v[28:31], v[68:71], v[88:103]
    s_waitcnt vmcnt(0)
    s_barrier
    s_add_u32 s35, s35, 1
    s_cmp_lt_u32 s35, 7
    s_cbranch_scc1 L_B_loop
    s_branch L_k2_fin
    s_nop 5
L_k2_A:
    s_lshl_b32 s36, s27, 12
    s_add_u32 s33, s33, s36
    s_add_u32 s34, s34, s36
    s_add_u32 s60, s58, 0
    s_mov_b32 m0, s60
    s_nop 0
    buffer_load_dwordx4 v126, s[20:23], s33 offen lds
    s_add_u32 s60, s58, 4096
    s_mov_b32 m0, s60
    s_nop 0
    buffer_load_dwordx4 v126, s[20:23], s34 offen lds
    s_cmp_lt_u32 s27, 1
    s_cbranch_scc1 L_A_ld_done
    s_sub_u32 s33, s33, 4096
    s_sub_u32 s34, s34, 4096
    s_add_u32 s60, s58, 8192
    s_mov_b32 m0, s60
    s_nop 0
    buffer_load_dwordx4 v126, s[20:23], s33 offen lds
    s_add_u32 s60, s58, 12288
    s_mov_b32 m0, s60
    s_nop 0
    buffer_load_dwordx4 v126, s[20:23], s34 offen lds
    s_cmp_lt_u32 s27, 2
    s_cbranch_scc1 L_A_ld_done
    s_sub_u32 s33, s33, 4096
    s_sub_u32 s34, s34, 4096
    s_add_u32 s60, s58, 16384
    s_mov_b32 m0, s60
    s_nop 0
    buffer_load_dwordx4 v126, s[20:23], s33 offen lds
    s_add_u32 s60, s58, 20480
    s_mov_b32 m0, s60
    s_nop 0
    buffer_load_dwordx4 v126, s[20:23], s34 offen lds
L_A_ld_done:
    s_waitcnt vmcnt(0)
    s_barrier
    s_min_u32 s37, s27, 2
    s_lshl_b32 s37, s37, 2
    s_sub_u32 s37, 8, s37
    s_cmp_eq_u32 s30, 0
    s_cbranch_scc0 L_A_w1
    ds_read_b128 v[8:11], v1 offset:0
    s_mov_b64 exec, s[50:51]
    ds_read_b128 v[16:19], v2 offset:4096
    ds_read_b128 v[20:23], v2 offset:4608
    s_mov_b64 exec, -1
    s_waitcnt lgkmcnt(0)
    v_cmp_gt_i32 vcc, 0, v3
    s_nop 1
    v_cndmask_b32 v104, v72, v127, vcc
    v_cmp_gt_i32 vcc, 1, v3
    s_nop 1
    v_cndmask_b32 v105, v73, v127, vcc
    v_cmp_gt_i32 vcc, 2, v3
    s_nop 1
    v_cndmask_b32 v106, v74, v127, vcc
    v_cmp_gt_i32 vcc, 3, v3
    s_nop 1
    v_cndmask_b32 v107, v75, v127, vcc
    v_cmp_gt_i32 vcc, 8, v3
    s_nop 1
    v_cndmask_b32 v108, v76, v127, vcc
    v_cmp_gt_i32 vcc, 9, v3
    s_nop 1
    v_cndmask_b32 v109, v77, v127, vcc
    v_cmp_gt_i32 vcc, 10, v3
    s_nop 1
    v_cndmask_b32 v110, v78, v127, vcc
    v_cmp_gt_i32 vcc, 11, v3
    s_nop 1
    v_cndmask_b32 v111, v79, v127, vcc
    v_cmp_gt_i32 vcc, 16, v3
    s_nop 1
    v_cndmask_b32 v112, v80, v127, vcc
    v_cmp_gt_i32 vcc, 17, v3
    s_nop 1
    v_cndmask_b32 v113, v81, v127, vcc
    v_cmp_gt_i32 vcc, 18, v3
    s_nop 1
    v_cndmask_b32 v114, v82, v127, vcc
    v_cmp_gt_i32 vcc, 19, v3
    s_nop 1
    v_cndmask_b32 v115, v83, v127, vcc
    v_cmp_gt_i32 vcc, 24, v3
    s_nop 1
    v_cndmask_b32 v116, v84, v127, vcc
    v_cmp_gt_i32 vcc, 25, v3
    s_nop 1
    v_cndmask_b32 v117, v85, v127, vcc
    v_cmp_gt_i32 vcc, 26, v3
    s_nop 1
    v_cndmask_b32 v118, v86, v127, vcc
    v_cmp_gt_i32 vcc, 27, v3
    s_nop 1
    v_cndmask_b32 v119, v87, v127, vcc
    s_nop 1
    v_mfma_f32_32x32x16_bf16 v[32:47], v[8:11], v[4:7], v[104:119]
    s_nop 11
    v_max3_f32 v120, v32, v33, v34
    v_max3_f32 v120, v120, v35, v36
    v_max3_f32 v120, v120, v37, v38
    v_max3_f32 v120, v120, v39, v40
    v_max3_f32 v120, v120, v41, v42
    v_max3_f32 v120, v120, v43, v44
    v_max3_f32 v120, v120, v45, v46
    v_max_f32 v120, v120, v47
    v_mov_b32 v121, v120
    s_nop 1
    v_permlane32_swap_b32 v121, v120
    v_max_f32 v120, v120, v121
    v_sub_f32 v32, v32, v120
    v_sub_f32 v33, v33, v120
    v_sub_f32 v34, v34, v120
    v_sub_f32 v35, v35, v120
    v_sub_f32 v36, v36, v120
    v_sub_f32 v37, v37, v120
    v_sub_f32 v38, v38, v120
    v_sub_f32 v39, v39, v120
    v_sub_f32 v40, v40, v120
    v_sub_f32 v41, v41, v120
    v_sub_f32 v42, v42, v120
    v_sub_f32 v43, v43, v120
    v_sub_f32 v44, v44, v120
    v_sub_f32 v45, v45, v120
    v_sub_f32 v46, v46, v120
    v_sub_f32 v47, v47, v120
    v_sub_f32 v72, v72, v120
    v_sub_f32 v73, v73, v120
    v_sub_f32 v74, v74, v120
    v_sub_f32 v75, v75, v120
    v_sub_f32 v76, v76, v120
    v_sub_f32 v77, v77, v120
    v_sub_f32 v78, v78, v120
    v_sub_f32 v79, v79, v120
    v_sub_f32 v80, v80, v120
    v_sub_f32 v81, v81, v120
    v_sub_f32 v82, v82, v120
    v_sub_f32 v83, v83, v120
    v_sub_f32 v84, v84, v120
    v_sub_f32 v85, v85, v120
    v_sub_f32 v86, v86, v120
    v_sub_f32 v87, v87, v120
    v_exp_f32 v32, v32
    v_exp_f32 v33, v33
    v_exp_f32 v34, v34
    v_exp_f32 v35, v35
    v_exp_f32 v36, v36
    v_exp_f32 v37, v37
    v_exp_f32 v38, v38
    v_exp_f32 v39, v39
    v_exp_f32 v40, v40
    v_exp_f32 v41, v41
    v_exp_f32 v42, v42
    v_exp_f32 v43, v43
    v_exp_f32 v44, v44
    v_exp_f32 v45, v45
    v_exp_f32 v46, v46
    v_exp_f32 v47, v47
    v_cvt_pk_bf16_f32 v64, v32, v33
    v_cvt_pk_bf16_f32 v65, v34, v35
    v_cvt_pk_bf16_f32 v66, v36, v37
    v_cvt_pk_bf16_f32 v67, v38, v39
    v_cvt_pk_bf16_f32 v68, v40, v41
    v_cvt_pk_bf16_f32 v69, v42, v43
    v_cvt_pk_bf16_f32 v70, v44, v45
    v_cvt_pk_bf16_f32 v71, v46, v47
    v_mfma_f32_32x32x16_bf16 v[88:103], v[16:19], v[64:67], v[88:103]
    s_nop 0
    v_mfma_f32_32x32x16_bf16 v[88:103], v[20:23], v[68:71], v[88:103]
    s_cmp_gt_u32 s37, 7
    s_cbranch_scc1 L_k2_fin
    ds_read_b128 v[8:11], v1 offset:11264
    s_mov_b64 exec, s[50:51]
    ds_read_b128 v[16:19], v2 offset:15360
    ds_read_b128 v[20:23], v2 offset:15872
    s_mov_b64 exec, -1
    s_waitcnt lgkmcnt(0)
    v_mfma_f32_32x32x16_bf16 v[32:47], v[8:11], v[4:7], v[72:87]
    s_nop 11
    v_max3_f32 v120, v32, v33, v34
    v_max3_f32 v120, v120, v35, v36
    v_max3_f32 v120, v120, v37, v38
    v_max3_f32 v120, v120, v39, v40
    v_max3_f32 v120, v120, v41, v42
    v_max3_f32 v120, v120, v43, v44
    v_max3_f32 v120, v120, v45, v46
    v_max_f32 v120, v120, v47
    v_cmp_lt_f32 vcc, s52, v120
    s_cbranch_vccnz L_rare_15
    s_nop 3
L_back_15:
    v_exp_f32 v32, v32
    v_exp_f32 v33, v33
    v_exp_f32 v34, v34
    v_exp_f32 v35, v35
    v_exp_f32 v36, v36
    v_exp_f32 v37, v37
    v_exp_f32 v38, v38
    v_exp_f32 v39, v39
    v_exp_f32 v40, v40
    v_exp_f32 v41, v41
    v_exp_f32 v42, v42
    v_exp_f32 v43, v43
    v_exp_f32 v44, v44
    v_exp_f32 v45, v45
    v_exp_f32 v46, v46
    v_exp_f32 v47, v47
    v_cvt_pk_bf16_f32 v64, v32, v33
    v_cvt_pk_bf16_f32 v65, v34, v35
    v_cvt_pk_bf16_f32 v66, v36, v37
    v_cvt_pk_bf16_f32 v67, v38, v39
    v_cvt_pk_bf16_f32 v68, v40, v41
    v_cvt_pk_bf16_f32 v69, v42, v43
    v_cvt_pk_bf16_f32 v70, v44, v45
    v_cvt_pk_bf16_f32 v71, v46, v47
    v_mfma_f32_32x32x16_bf16 v[88:103], v[16:19], v[64:67], v[88:103]
    s_nop 0
    v_mfma_f32_32x32x16_bf16 v[88:103], v[20:23], v[68:71], v[88:103]
    s_cmp_gt_u32 s37, 6
    s_cbranch_scc1 L_k2_fin
    ds_read_b128 v[8:11], v1 offset:10240
    s_mov_b64 exec, s[50:51]
    ds_read_b128 v[16:19], v2 offset:14336
    ds_read_b128 v[20:23], v2 offset:14848
    s_mov_b64 exec, -1
    s_waitcnt lgkmcnt(0)
    v_mfma_f32_32x32x16_bf16 v[32:47], v[8:11], v[4:7], v[72:87]
    s_nop 11
    v_max3_f32 v120, v32, v33, v34
    v_max3_f32 v120, v120, v35, v36
    v_max3_f32 v120, v120, v37, v38
    v_max3_f32 v120, v120, v39, v40
    v_max3_f32 v120, v120, v41, v42
    v_max3_f32 v120, v120, v43, v44
    v_max3_f32 v120, v120, v45, v46
    v_max_f32 v120, v120, v47
    v_cmp_lt_f32 vcc, s52, v120
    s_cbranch_vccnz L_rare_16
    s_nop 3
L_back_16:
    v_exp_f32 v32, v32
    v_exp_f32 v33, v33
    v_exp_f32 v34, v34
    v_exp_f32 v35, v35
    v_exp_f32 v36, v36
    v_exp_f32 v37, v37
    v_exp_f32 v38, v38
    v_exp_f32 v39, v39
    v_exp_f32 v40, v40
    v_exp_f32 v41, v41
    v_exp_f32 v42, v42
    v_exp_f32 v43, v43
    v_exp_f32 v44, v44
    v_exp_f32 v45, v45
    v_exp_f32 v46, v46
    v_exp_f32 v47, v47
    v_cvt_pk_bf16_f32 v64, v32, v33
    v_cvt_pk_bf16_f32 v65, v34, v35
    v_cvt_pk_bf16_f32 v66, v36, v37
    v_cvt_pk_bf16_f32 v67, v38, v39
    v_cvt_pk_bf16_f32 v68, v40, v41
    v_cvt_pk_bf16_f32 v69, v42, v43
    v_cvt_pk_bf16_f32 v70, v44, v45
    v_cvt_pk_bf16_f32 v71, v46, v47
    v_mfma_f32_32x32x16_bf16 v[88:103], v[16:19], v[64:67], v[88:103]
    s_nop 0
    v_mfma_f32_32x32x16_bf16 v[88:103], v[20:23], v[68:71], v[88:103]
    s_cmp_gt_u32 s37, 5
    s_cbranch_scc1 L_k2_fin
    ds_read_b128 v[8:11], v1 offset:9216
    s_mov_b64 exec, s[50:51]
    ds_read_b128 v[16:19], v2 offset:13312
    ds_read_b128 v[20:23], v2 offset:13824
    s_mov_b64 exec, -1
    s_waitcnt lgkmcnt(0)
    v_mfma_f32_32x32x16_bf16 v[32:47], v[8:11], v[4:7], v[72:87]
    s_nop 11
    v_max3_f32 v120, v32, v33, v34
    v_max3_f32 v120, v120, v35, v36
    v_max3_f32 v120, v120, v37, v38
    v_max3_f32 v120, v120, v39, v40
    v_max3_f32 v120, v120, v41, v42
    v_max3_f32 v120, v120, v43, v44
    v_max3_f32 v120, v120, v45, v46
    v_max_f32 v120, v120, v47
    v_cmp_lt_f32 vcc, s52, v120
    s_cbranch_vccnz L_rare_17
    s_nop 3
L_back_17:
    v_exp_f32 v32, v32
    v_exp_f32 v33, v33
    v_exp_f32 v34, v34
    v_exp_f32 v35, v35
    v_exp_f32 v36, v36
    v_exp_f32 v37, v37
    v_exp_f32 v38, v38
    v_exp_f32 v39, v39
    v_exp_f32 v40, v40
    v_exp_f32 v41, v41
    v_exp_f32 v42, v42
    v_exp_f32 v43, v43
    v_exp_f32 v44, v44
    v_exp_f32 v45, v45
    v_exp_f32 v46, v46
    v_exp_f32 v47, v47
    v_cvt_pk_bf16_f32 v64, v32, v33
    v_cvt_pk_bf16_f32 v65, v34, v35
    v_cvt_pk_bf16_f32 v66, v36, v37
    v_cvt_pk_bf16_f32 v67, v38, v39
    v_cvt_pk_bf16_f32 v68, v40, v41
    v_cvt_pk_bf16_f32 v69, v42, v43
    v_cvt_pk_bf16_f32 v70, v44, v45
    v_cvt_pk_bf16_f32 v71, v46, v47
    v_mfma_f32_32x32x16_bf16 v[88:103], v[16:19], v[64:67], v[88:103]
    s_nop 0
    v_mfma_f32_32x32x16_bf16 v[88:103], v[20:23], v[68:71], v[88:103]
    s_cmp_gt_u32 s37, 4
    s_cbranch_scc1 L_k2_fin
    ds_read_b128 v[8:11], v1 offset:8192
    s_mov_b64 exec, s[50:51]
    ds_read_b128 v[16:19], v2 offset:12288
    ds_read_b128 v[20:23], v2 offset:12800
    s_mov_b64 exec, -1
    s_waitcnt lgkmcnt(0)
    v_mfma_f32_32x32x16_bf16 v[32:47], v[8:11], v[4:7], v[72:87]
    s_nop 11
    v_max3_f32 v120, v32, v33, v34
    v_max3_f32 v120, v120, v35, v36
    v_max3_f32 v120, v120, v37, v38
    v_max3_f32 v120, v120, v39, v40
    v_max3_f32 v120, v120, v41, v42
    v_max3_f32 v120, v120, v43, v44
    v_max3_f32 v120, v120, v45, v46
    v_max_f32 v120, v120, v47
    v_cmp_lt_f32 vcc, s52, v120
    s_cbranch_vccnz L_rare_18
    s_nop 3
L_back_18:
    v_exp_f32 v32, v32
    v_exp_f32 v33, v33
    v_exp_f32 v34, v34
    v_exp_f32 v35, v35
    v_exp_f32 v36, v36
    v_exp_f32 v37, v37
    v_exp_f32 v38, v38
    v_exp_f32 v39, v39
    v_exp_f32 v40, v40
    v_exp_f32 v41, v41
    v_exp_f32 v42, v42
    v_exp_f32 v43, v43
    v_exp_f32 v44, v44
    v_exp_f32 v45, v45
    v_exp_f32 v46, v46
    v_exp_f32 v47, v47
    v_cvt_pk_bf16_f32 v64, v32, v33
    v_cvt_pk_bf16_f32 v65, v34, v35
    v_cvt_pk_bf16_f32 v66, v36, v37
    v_cvt_pk_bf16_f32 v67, v38, v39
    v_cvt_pk_bf16_f32 v68, v40, v41
    v_cvt_pk_bf16_f32 v69, v42, v43
    v_cvt_pk_bf16_f32 v70, v44, v45
    v_cvt_pk_bf16_f32 v71, v46, v47
    v_mfma_f32_32x32x16_bf16 v[88:103], v[16:19], v[64:67], v[88:103]
    s_nop 0
    v_mfma_f32_32x32x16_bf16 v[88:103], v[20:23], v[68:71], v[88:103]
    s_cmp_gt_u32 s37, 3
    s_cbranch_scc1 L_k2_fin
    ds_read_b128 v[8:11], v1 offset:19456
    s_mov_b64 exec, s[50:51]
    ds_read_b128 v[16:19], v2 offset:23552
    ds_read_b128 v[20:23], v2 offset:24064
    s_mov_b64 exec, -1
    s_waitcnt lgkmcnt(0)
    v_mfma_f32_32x32x16_bf16 v[32:47], v[8:11], v[4:7], v[72:87]
    s_nop 11
    v_max3_f32 v120, v32, v33, v34
    v_max3_f32 v120, v120, v35, v36
    v_max3_f32 v120, v120, v37, v38
    v_max3_f32 v120, v120, v39, v40
    v_max3_f32 v120, v120, v41, v42
    v_max3_f32 v120, v120, v43, v44
    v_max3_f32 v120, v120, v45, v46
    v_max_f32 v120, v120, v47
    v_cmp_lt_f32 vcc, s52, v120
    s_cbranch_vccnz L_rare_19
    s_nop 3
L_back_19:
    v_exp_f32 v32, v32
    v_exp_f32 v33, v33
    v_exp_f32 v34, v34
    v_exp_f32 v35, v35
    v_exp_f32 v36, v36
    v_exp_f32 v37, v37
    v_exp_f32 v38, v38
    v_exp_f32 v39, v39
    v_exp_f32 v40, v40
    v_exp_f32 v41, v41
    v_exp_f32 v42, v42
    v_exp_f32 v43, v43
    v_exp_f32 v44, v44
    v_exp_f32 v45, v45
    v_exp_f32 v46, v46
    v_exp_f32 v47, v47
    v_cvt_pk_bf16_f32 v64, v32, v33
    v_cvt_pk_bf16_f32 v65, v34, v35
    v_cvt_pk_bf16_f32 v66, v36, v37
    v_cvt_pk_bf16_f32 v67, v38, v39
    v_cvt_pk_bf16_f32 v68, v40, v41
    v_cvt_pk_bf16_f32 v69, v42, v43
    v_cvt_pk_bf16_f32 v70, v44, v45
    v_cvt_pk_bf16_f32 v71, v46, v47
    v_mfma_f32_32x32x16_bf16 v[88:103], v[16:19], v[64:67], v[88:103]
    s_nop 0
    v_mfma_f32_32x32x16_bf16 v[88:103], v[20:23], v[68:71], v[88:103]
    s_cmp_gt_u32 s37, 2
    s_cbranch_scc1 L_k2_fin
    ds_read_b128 v[8:11], v1 offset:18432
    s_mov_b64 exec, s[50:51]
    ds_read_b128 v[16:19], v2 offset:22528
    ds_read_b128 v[20:23], v2 offset:23040
    s_mov_b64 exec, -1
    s_waitcnt lgkmcnt(0)
    v_mfma_f32_32x32x16_bf16 v[32:47], v[8:11], v[4:7], v[72:87]
    s_nop 11
    v_max3_f32 v120, v32, v33, v34
    v_max3_f32 v120, v120, v35, v36
    v_max3_f32 v120, v120, v37, v38
    v_max3_f32 v120, v120, v39, v40
    v_max3_f32 v120, v120, v41, v42
    v_max3_f32 v120, v120, v43, v44
    v_max3_f32 v120, v120, v45, v46
    v_max_f32 v120, v120, v47
    v_cmp_lt_f32 vcc, s52, v120
    s_cbranch_vccnz L_rare_20
    s_nop 3
L_back_20:
    v_exp_f32 v32, v32
    v_exp_f32 v33, v33
    v_exp_f32 v34, v34
    v_exp_f32 v35, v35
    v_exp_f32 v36, v36
    v_exp_f32 v37, v37
    v_exp_f32 v38, v38
    v_exp_f32 v39, v39
    v_exp_f32 v40, v40
    v_exp_f32 v41, v41
    v_exp_f32 v42, v42
    v_exp_f32 v43, v43
    v_exp_f32 v44, v44
    v_exp_f32 v45, v45
    v_exp_f32 v46, v46
    v_exp_f32 v47, v47
    v_cvt_pk_bf16_f32 v64, v32, v33
    v_cvt_pk_bf16_f32 v65, v34, v35
    v_cvt_pk_bf16_f32 v66, v36, v37
    v_cvt_pk_bf16_f32 v67, v38, v39
    v_cvt_pk_bf16_f32 v68, v40, v41
    v_cvt_pk_bf16_f32 v69, v42, v43
    v_cvt_pk_bf16_f32 v70, v44, v45
    v_cvt_pk_bf16_f32 v71, v46, v47
    v_mfma_f32_32x32x16_bf16 v[88:103], v[16:19], v[64:67], v[88:103]
    s_nop 0
    v_mfma_f32_32x32x16_bf16 v[88:103], v[20:23], v[68:71], v[88:103]
    s_cmp_gt_u32 s37, 1
    s_cbranch_scc1 L_k2_fin
    ds_read_b128 v[8:11], v1 offset:17408
    s_mov_b64 exec, s[50:51]
    ds_read_b128 v[16:19], v2 offset:21504
    ds_read_b128 v[20:23], v2 offset:22016
    s_mov_b64 exec, -1
    s_waitcnt lgkmcnt(0)
    v_mfma_f32_32x32x16_bf16 v[32:47], v[8:11], v[4:7], v[72:87]
    s_nop 11
    v_max3_f32 v120, v32, v33, v34
    v_max3_f32 v120, v120, v35, v36
    v_max3_f32 v120, v120, v37, v38
    v_max3_f32 v120, v120, v39, v40
    v_max3_f32 v120, v120, v41, v42
    v_max3_f32 v120, v120, v43, v44
    v_max3_f32 v120, v120, v45, v46
    v_max_f32 v120, v120, v47
    v_cmp_lt_f32 vcc, s52, v120
    s_cbranch_vccnz L_rare_21
    s_nop 3
L_back_21:
    v_exp_f32 v32, v32
    v_exp_f32 v33, v33
    v_exp_f32 v34, v34
    v_exp_f32 v35, v35
    v_exp_f32 v36, v36
    v_exp_f32 v37, v37
    v_exp_f32 v38, v38
    v_exp_f32 v39, v39
    v_exp_f32 v40, v40
    v_exp_f32 v41, v41
    v_exp_f32 v42, v42
    v_exp_f32 v43, v43
    v_exp_f32 v44, v44
    v_exp_f32 v45, v45
    v_exp_f32 v46, v46
    v_exp_f32 v47, v47
    v_cvt_pk_bf16_f32 v64, v32, v33
    v_cvt_pk_bf16_f32 v65, v34, v35
    v_cvt_pk_bf16_f32 v66, v36, v37
    v_cvt_pk_bf16_f32 v67, v38, v39
    v_cvt_pk_bf16_f32 v68, v40, v41
    v_cvt_pk_bf16_f32 v69, v42, v43
    v_cvt_pk_bf16_f32 v70, v44, v45
    v_cvt_pk_bf16_f32 v71, v46, v47
    v_mfma_f32_32x32x16_bf16 v[88:103], v[16:19], v[64:67], v[88:103]
    s_nop 0
    v_mfma_f32_32x32x16_bf16 v[88:103], v[20:23], v[68:71], v[88:103]
    s_cmp_gt_u32 s37, 0
    s_cbranch_scc1 L_k2_fin
    ds_read_b128 v[8:11], v1 offset:16384
    s_mov_b64 exec, s[50:51]
    ds_read_b128 v[16:19], v2 offset:20480
    ds_read_b128 v[20:23], v2 offset:20992
    s_mov_b64 exec, -1
    s_waitcnt lgkmcnt(0)
    v_cmp_le_i32 vcc, 0, v3
    s_nop 1
    v_cndmask_b32 v104, v72, v127, vcc
    v_cmp_le_i32 vcc, 1, v3
    s_nop 1
    v_cndmask_b32 v105, v73, v127, vcc
    v_cmp_le_i32 vcc, 2, v3
    s_nop 1
    v_cndmask_b32 v106, v74, v127, vcc
    v_cmp_le_i32 vcc, 3, v3
    s_nop 1
    v_cndmask_b32 v107, v75, v127, vcc
    v_cmp_le_i32 vcc, 8, v3
    s_nop 1
    v_cndmask_b32 v108, v76, v127, vcc
    v_cmp_le_i32 vcc, 9, v3
    s_nop 1
    v_cndmask_b32 v109, v77, v127, vcc
    v_cmp_le_i32 vcc, 10, v3
    s_nop 1
    v_cndmask_b32 v110, v78, v127, vcc
    v_cmp_le_i32 vcc, 11, v3
    s_nop 1
    v_cndmask_b32 v111, v79, v127, vcc
    v_cmp_le_i32 vcc, 16, v3
    s_nop 1
    v_cndmask_b32 v112, v80, v127, vcc
    v_cmp_le_i32 vcc, 17, v3
    s_nop 1
    v_cndmask_b32 v113, v81, v127, vcc
    v_cmp_le_i32 vcc, 18, v3
    s_nop 1
    v_cndmask_b32 v114, v82, v127, vcc
    v_cmp_le_i32 vcc, 19, v3
    s_nop 1
    v_cndmask_b32 v115, v83, v127, vcc
    v_cmp_le_i32 vcc, 24, v3
    s_nop 1
    v_cndmask_b32 v116, v84, v127, vcc
    v_cmp_le_i32 vcc, 25, v3
    s_nop 1
    v_cndmask_b32 v117, v85, v127, vcc
    v_cmp_le_i32 vcc, 26, v3
    s_nop 1
    v_cndmask_b32 v118, v86, v127, vcc
    v_cmp_le_i32 vcc, 27, v3
    s_nop 1
    v_cndmask_b32 v119, v87, v127, vcc
    s_nop 1
    v_mfma_f32_32x32x16_bf16 v[32:47], v[8:11], v[4:7], v[104:119]
    s_nop 11
    v_max3_f32 v120, v32, v33, v34
    v_max3_f32 v120, v120, v35, v36
    v_max3_f32 v120, v120, v37, v38
    v_max3_f32 v120, v120, v39, v40
    v_max3_f32 v120, v120, v41, v42
    v_max3_f32 v120, v120, v43, v44
    v_max3_f32 v120, v120, v45, v46
    v_max_f32 v120, v120, v47
    v_cmp_lt_f32 vcc, s52, v120
    s_cbranch_vccnz L_rare_22
    s_nop 3
L_back_22:
    v_exp_f32 v32, v32
    v_exp_f32 v33, v33
    v_exp_f32 v34, v34
    v_exp_f32 v35, v35
    v_exp_f32 v36, v36
    v_exp_f32 v37, v37
    v_exp_f32 v38, v38
    v_exp_f32 v39, v39
    v_exp_f32 v40, v40
    v_exp_f32 v41, v41
    v_exp_f32 v42, v42
    v_exp_f32 v43, v43
    v_exp_f32 v44, v44
    v_exp_f32 v45, v45
    v_exp_f32 v46, v46
    v_exp_f32 v47, v47
    v_cvt_pk_bf16_f32 v64, v32, v33
    v_cvt_pk_bf16_f32 v65, v34, v35
    v_cvt_pk_bf16_f32 v66, v36, v37
    v_cvt_pk_bf16_f32 v67, v38, v39
    v_cvt_pk_bf16_f32 v68, v40, v41
    v_cvt_pk_bf16_f32 v69, v42, v43
    v_cvt_pk_bf16_f32 v70, v44, v45
    v_cvt_pk_bf16_f32 v71, v46, v47
    v_mfma_f32_32x32x16_bf16 v[88:103], v[16:19], v[64:67], v[88:103]
    s_nop 0
    v_mfma_f32_32x32x16_bf16 v[88:103], v[20:23], v[68:71], v[88:103]
    s_branch L_k2_fin
    s_nop 10
L_A_w1:
    s_cmp_eq_u32 s30, 1
    s_cbranch_scc0 L_A_w2
    ds_read_b128 v[8:11], v1 offset:1024
    s_mov_b64 exec, s[50:51]
    ds_read_b128 v[16:19], v2 offset:5120
    ds_read_b128 v[20:23], v2 offset:5632
    s_mov_b64 exec, -1
    s_waitcnt lgkmcnt(0)
    v_cmp_gt_i32 vcc, 0, v3
    s_nop 1
    v_cndmask_b32 v104, v72, v127, vcc
    v_cmp_gt_i32 vcc, 1, v3
    s_nop 1
    v_cndmask_b32 v105, v73, v127, vcc
    v_cmp_gt_i32 vcc, 2, v3
    s_nop 1
    v_cndmask_b32 v106, v74, v127, vcc
    v_cmp_gt_i32 vcc, 3, v3
    s_nop 1
    v_cndmask_b32 v107, v75, v127, vcc
    v_cmp_gt_i32 vcc, 8, v3
    s_nop 1
    v_cndmask_b32 v108, v76, v127, vcc
    v_cmp_gt_i32 vcc, 9, v3
    s_nop 1
    v_cndmask_b32 v109, v77, v127, vcc
    v_cmp_gt_i32 vcc, 10, v3
    s_nop 1
    v_cndmask_b32 v110, v78, v127, vcc
    v_cmp_gt_i32 vcc, 11, v3
    s_nop 1
    v_cndmask_b32 v111, v79, v127, vcc
    v_cmp_gt_i32 vcc, 16, v3
    s_nop 1
    v_cndmask_b32 v112, v80, v127, vcc
    v_cmp_gt_i32 vcc, 17, v3
    s_nop 1
    v_cndmask_b32 v113, v81, v127, vcc
    v_cmp_gt_i32 vcc, 18, v3
    s_nop 1
    v_cndmask_b32 v114, v82, v127, vcc
    v_cmp_gt_i32 vcc, 19, v3
    s_nop 1
    v_cndmask_b32 v115, v83, v127, vcc
    v_cmp_gt_i32 vcc, 24, v3
    s_nop 1
    v_cndmask_b32 v116, v84, v127, vcc
    v_cmp_gt_i32 vcc, 25, v3
    s_nop 1
    v_cndmask_b32 v117, v85, v127, vcc
    v_cmp_gt_i32 vcc, 26, v3
    s_nop 1
    v_cndmask_b32 v118, v86, v127, vcc
    v_cmp_gt_i32 vcc, 27, v3
    s_nop 1
    v_cndmask_b32 v119, v87, v127, vcc
    s_nop 1
    v_mfma_f32_32x32x16_bf16 v[32:47], v[8:11], v[4:7], v[104:119]
    s_nop 11
    v_max3_f32 v120, v32, v33, v34
    v_max3_f32 v120, v120, v35, v36
    v_max3_f32 v120, v120, v37, v38
    v_max3_f32 v120, v120, v39, v40
    v_max3_f32 v120, v120, v41, v42
    v_max3_f32 v120, v120, v43, v44
    v_max3_f32 v120, v120, v45, v46
    v_max_f32 v120, v120, v47
    v_mov_b32 v121, v120
    s_nop 1
    v_permlane32_swap_b32 v121, v120
    v_max_f32 v120, v120, v121
    v_sub_f32 v32, v32, v120
    v_sub_f32 v33, v33, v120
    v_sub_f32 v34, v34, v120
    v_sub_f32 v35, v35, v120
    v_sub_f32 v36, v36, v120
    v_sub_f32 v37, v37, v120
    v_sub_f32 v38, v38, v120
    v_sub_f32 v39, v39, v120
    v_sub_f32 v40, v40, v120
    v_sub_f32 v41, v41, v120
    v_sub_f32 v42, v42, v120
    v_sub_f32 v43, v43, v120
    v_sub_f32 v44, v44, v120
    v_sub_f32 v45, v45, v120
    v_sub_f32 v46, v46, v120
    v_sub_f32 v47, v47, v120
    v_sub_f32 v72, v72, v120
    v_sub_f32 v73, v73, v120
    v_sub_f32 v74, v74, v120
    v_sub_f32 v75, v75, v120
    v_sub_f32 v76, v76, v120
    v_sub_f32 v77, v77, v120
    v_sub_f32 v78, v78, v120
    v_sub_f32 v79, v79, v120
    v_sub_f32 v80, v80, v120
    v_sub_f32 v81, v81, v120
    v_sub_f32 v82, v82, v120
    v_sub_f32 v83, v83, v120
    v_sub_f32 v84, v84, v120
    v_sub_f32 v85, v85, v120
    v_sub_f32 v86, v86, v120
    v_sub_f32 v87, v87, v120
    v_exp_f32 v32, v32
    v_exp_f32 v33, v33
    v_exp_f32 v34, v34
    v_exp_f32 v35, v35
    v_exp_f32 v36, v36
    v_exp_f32 v37, v37
    v_exp_f32 v38, v38
    v_exp_f32 v39, v39
    v_exp_f32 v40, v40
    v_exp_f32 v41, v41
    v_exp_f32 v42, v42
    v_exp_f32 v43, v43
    v_exp_f32 v44, v44
    v_exp_f32 v45, v45
    v_exp_f32 v46, v46
    v_exp_f32 v47, v47
    v_cvt_pk_bf16_f32 v64, v32, v33
    v_cvt_pk_bf16_f32 v65, v34, v35
    v_cvt_pk_bf16_f32 v66, v36, v37
    v_cvt_pk_bf16_f32 v67, v38, v39
    v_cvt_pk_bf16_f32 v68, v40, v41
    v_cvt_pk_bf16_f32 v69, v42, v43
    v_cvt_pk_bf16_f32 v70, v44, v45
    v_cvt_pk_bf16_f32 v71, v46, v47
    v_mfma_f32_32x32x16_bf16 v[88:103], v[16:19], v[64:67], v[88:103]
    s_nop 0
    v_mfma_f32_32x32x16_bf16 v[88:103], v[20:23], v[68:71], v[88:103]
    ds_read_b128 v[8:11], v1 offset:0
    s_mov_b64 exec, s[50:51]
    ds_read_b128 v[16:19], v2 offset:4096
    ds_read_b128 v[20:23], v2 offset:4608
    s_mov_b64 exec, -1
    s_waitcnt lgkmcnt(0)
    v_mfma_f32_32x32x16_bf16 v[32:47], v[8:11], v[4:7], v[72:87]
    s_nop 11
    v_max3_f32 v120, v32, v33, v34
    v_max3_f32 v120, v120, v35, v36
    v_max3_f32 v120, v120, v37, v38
    v_max3_f32 v120, v120, v39, v40
    v_max3_f32 v120, v120, v41, v42
    v_max3_f32 v120, v120, v43, v44
    v_max3_f32 v120, v120, v45, v46
    v_max_f32 v120, v120, v47
    v_cmp_lt_f32 vcc, s52, v120
    s_cbranch_vccnz L_rare_23
    s_nop 3
L_back_23:
    v_exp_f32 v32, v32
    v_exp_f32 v33, v33
    v_exp_f32 v34, v34
    v_exp_f32 v35, v35
    v_exp_f32 v36, v36
    v_exp_f32 v37, v37
    v_exp_f32 v38, v38
    v_exp_f32 v39, v39
    v_exp_f32 v40, v40
    v_exp_f32 v41, v41
    v_exp_f32 v42, v42
    v_exp_f32 v43, v43
    v_exp_f32 v44, v44
    v_exp_f32 v45, v45
    v_exp_f32 v46, v46
    v_exp_f32 v47, v47
    v_cvt_pk_bf16_f32 v64, v32, v33
    v_cvt_pk_bf16_f32 v65, v34, v35
    v_cvt_pk_bf16_f32 v66, v36, v37
    v_cvt_pk_bf16_f32 v67, v38, v39
    v_cvt_pk_bf16_f32 v68, v40, v41
    v_cvt_pk_bf16_f32 v69, v42, v43
    v_cvt_pk_bf16_f32 v70, v44, v45
    v_cvt_pk_bf16_f32 v71, v46, v47
    v_mfma_f32_32x32x16_bf16 v[88:103], v[16:19], v[64:67], v[88:103]
    s_nop 0
    v_mfma_f32_32x32x16_bf16 v[88:103], v[20:23], v[68:71], v[88:103]
    s_cmp_gt_u32 s37, 7
    s_cbranch_scc1 L_k2_fin
    ds_read_b128 v[8:11], v1 offset:11264
    s_mov_b64 exec, s[50:51]
    ds_read_b128 v[16:19], v2 offset:15360
    ds_read_b128 v[20:23], v2 offset:15872
    s_mov_b64 exec, -1
    s_waitcnt lgkmcnt(0)
    v_mfma_f32_32x32x16_bf16 v[32:47], v[8:11], v[4:7], v[72:87]
    s_nop 11
    v_max3_f32 v120, v32, v33, v34
    v_max3_f32 v120, v120, v35, v36
    v_max3_f32 v120, v120, v37, v38
    v_max3_f32 v120, v120, v39, v40
    v_max3_f32 v120, v120, v41, v42
    v_max3_f32 v120, v120, v43, v44
    v_max3_f32 v120, v120, v45, v46
    v_max_f32 v120, v120, v47
    v_cmp_lt_f32 vcc, s52, v120
    s_cbranch_vccnz L_rare_24
    s_nop 3
L_back_24:
    v_exp_f32 v32, v32
    v_exp_f32 v33, v33
    v_exp_f32 v34, v34
    v_exp_f32 v35, v35
    v_exp_f32 v36, v36
    v_exp_f32 v37, v37
    v_exp_f32 v38, v38
    v_exp_f32 v39, v39
    v_exp_f32 v40, v40
    v_exp_f32 v41, v41
    v_exp_f32 v42, v42
    v_exp_f32 v43, v43
    v_exp_f32 v44, v44
    v_exp_f32 v45, v45
    v_exp_f32 v46, v46
    v_exp_f32 v47, v47
    v_cvt_pk_bf16_f32 v64, v32, v33
    v_cvt_pk_bf16_f32 v65, v34, v35
    v_cvt_pk_bf16_f32 v66, v36, v37
    v_cvt_pk_bf16_f32 v67, v38, v39
    v_cvt_pk_bf16_f32 v68, v40, v41
    v_cvt_pk_bf16_f32 v69, v42, v43
    v_cvt_pk_bf16_f32 v70, v44, v45
    v_cvt_pk_bf16_f32 v71, v46, v47
    v_mfma_f32_32x32x16_bf16 v[88:103], v[16:19], v[64:67], v[88:103]
    s_nop 0
    v_mfma_f32_32x32x16_bf16 v[88:103], v[20:23], v[68:71], v[88:103]
    s_cmp_gt_u32 s37, 6
    s_cbranch_scc1 L_k2_fin
    ds_read_b128 v[8:11], v1 offset:10240
    s_mov_b64 exec, s[50:51]
    ds_read_b128 v[16:19], v2 offset:14336
    ds_read_b128 v[20:23], v2 offset:14848
    s_mov_b64 exec, -1
    s_waitcnt lgkmcnt(0)
    v_mfma_f32_32x32x16_bf16 v[32:47], v[8:11], v[4:7], v[72:87]
    s_nop 11
    v_max3_f32 v120, v32, v33, v34
    v_max3_f32 v120, v120, v35, v36
    v_max3_f32 v120, v120, v37, v38
    v_max3_f32 v120, v120, v39, v40
    v_max3_f32 v120, v120, v41, v42
    v_max3_f32 v120, v120, v43, v44
    v_max3_f32 v120, v120, v45, v46
    v_max_f32 v120, v120, v47
    v_cmp_lt_f32 vcc, s52, v120
    s_cbranch_vccnz L_rare_25
    s_nop 3
L_back_25:
    v_exp_f32 v32, v32
    v_exp_f32 v33, v33
    v_exp_f32 v34, v34
    v_exp_f32 v35, v35
    v_exp_f32 v36, v36
    v_exp_f32 v37, v37
    v_exp_f32 v38, v38
    v_exp_f32 v39, v39
    v_exp_f32 v40, v40
    v_exp_f32 v41, v41
    v_exp_f32 v42, v42
    v_exp_f32 v43, v43
    v_exp_f32 v44, v44
    v_exp_f32 v45, v45
    v_exp_f32 v46, v46
    v_exp_f32 v47, v47
    v_cvt_pk_bf16_f32 v64, v32, v33
    v_cvt_pk_bf16_f32 v65, v34, v35
    v_cvt_pk_bf16_f32 v66, v36, v37
    v_cvt_pk_bf16_f32 v67, v38, v39
    v_cvt_pk_bf16_f32 v68, v40, v41
    v_cvt_pk_bf16_f32 v69, v42, v43
    v_cvt_pk_bf16_f32 v70, v44, v45
    v_cvt_pk_bf16_f32 v71, v46, v47
    v_mfma_f32_32x32x16_bf16 v[88:103], v[16:19], v[64:67], v[88:103]
    s_nop 0
    v_mfma_f32_32x32x16_bf16 v[88:103], v[20:23], v[68:71], v[88:103]
    s_cmp_gt_u32 s37, 5
    s_cbranch_scc1 L_k2_fin
    ds_read_b128 v[8:11], v1 offset:9216
    s_mov_b64 exec, s[50:51]
    ds_read_b128 v[16:19], v2 offset:13312
    ds_read_b128 v[20:23], v2 offset:13824
    s_mov_b64 exec, -1
    s_waitcnt lgkmcnt(0)
    v_mfma_f32_32x32x16_bf16 v[32:47], v[8:11], v[4:7], v[72:87]
    s_nop 11
    v_max3_f32 v120, v32, v33, v34
    v_max3_f32 v120, v120, v35, v36
    v_max3_f32 v120, v120, v37, v38
    v_max3_f32 v120, v120, v39, v40
    v_max3_f32 v120, v120, v41, v42
    v_max3_f32 v120, v120, v43, v44
    v_max3_f32 v120, v120, v45, v46
    v_max_f32 v120, v120, v47
    v_cmp_lt_f32 vcc, s52, v120
    s_cbranch_vccnz L_rare_26
    s_nop 3
L_back_26:
    v_exp_f32 v32, v32
    v_exp_f32 v33, v33
    v_exp_f32 v34, v34
    v_exp_f32 v35, v35
    v_exp_f32 v36, v36
    v_exp_f32 v37, v37
    v_exp_f32 v38, v38
    v_exp_f32 v39, v39
    v_exp_f32 v40, v40
    v_exp_f32 v41, v41
    v_exp_f32 v42, v42
    v_exp_f32 v43, v43
    v_exp_f32 v44, v44
    v_exp_f32 v45, v45
    v_exp_f32 v46, v46
    v_exp_f32 v47, v47
    v_cvt_pk_bf16_f32 v64, v32, v33
    v_cvt_pk_bf16_f32 v65, v34, v35
    v_cvt_pk_bf16_f32 v66, v36, v37
    v_cvt_pk_bf16_f32 v67, v38, v39
    v_cvt_pk_bf16_f32 v68, v40, v41
    v_cvt_pk_bf16_f32 v69, v42, v43
    v_cvt_pk_bf16_f32 v70, v44, v45
    v_cvt_pk_bf16_f32 v71, v46, v47
    v_mfma_f32_32x32x16_bf16 v[88:103], v[16:19], v[64:67], v[88:103]
    s_nop 0
    v_mfma_f32_32x32x16_bf16 v[88:103], v[20:23], v[68:71], v[88:103]
    s_cmp_gt_u32 s37, 4
    s_cbranch_scc1 L_k2_fin
    ds_read_b128 v[8:11], v1 offset:8192
    s_mov_b64 exec, s[50:51]
    ds_read_b128 v[16:19], v2 offset:12288
    ds_read_b128 v[20:23], v2 offset:12800
    s_mov_b64 exec, -1
    s_waitcnt lgkmcnt(0)
    v_mfma_f32_32x32x16_bf16 v[32:47], v[8:11], v[4:7], v[72:87]
    s_nop 11
    v_max3_f32 v120, v32, v33, v34
    v_max3_f32 v120, v120, v35, v36
    v_max3_f32 v120, v120, v37, v38
    v_max3_f32 v120, v120, v39, v40
    v_max3_f32 v120, v120, v41, v42
    v_max3_f32 v120, v120, v43, v44
    v_max3_f32 v120, v120, v45, v46
    v_max_f32 v120, v120, v47
    v_cmp_lt_f32 vcc, s52, v120
    s_cbranch_vccnz L_rare_27
    s_nop 3
L_back_27:
    v_exp_f32 v32, v32
    v_exp_f32 v33, v33
    v_exp_f32 v34, v34
    v_exp_f32 v35, v35
    v_exp_f32 v36, v36
    v_exp_f32 v37, v37
    v_exp_f32 v38, v38
    v_exp_f32 v39, v39
    v_exp_f32 v40, v40
    v_exp_f32 v41, v41
    v_exp_f32 v42, v42
    v_exp_f32 v43, v43
    v_exp_f32 v44, v44
    v_exp_f32 v45, v45
    v_exp_f32 v46, v46
    v_exp_f32 v47, v47
    v_cvt_pk_bf16_f32 v64, v32, v33
    v_cvt_pk_bf16_f32 v65, v34, v35
    v_cvt_pk_bf16_f32 v66, v36, v37
    v_cvt_pk_bf16_f32 v67, v38, v39
    v_cvt_pk_bf16_f32 v68, v40, v41
    v_cvt_pk_bf16_f32 v69, v42, v43
    v_cvt_pk_bf16_f32 v70, v44, v45
    v_cvt_pk_bf16_f32 v71, v46, v47
    v_mfma_f32_32x32x16_bf16 v[88:103], v[16:19], v[64:67], v[88:103]
    s_nop 0
    v_mfma_f32_32x32x16_bf16 v[88:103], v[20:23], v[68:71], v[88:103]
    s_cmp_gt_u32 s37, 3
    s_cbranch_scc1 L_k2_fin
    ds_read_b128 v[8:11], v1 offset:19456
    s_mov_b64 exec, s[50:51]
    ds_read_b128 v[16:19], v2 offset:23552
    ds_read_b128 v[20:23], v2 offset:24064
    s_mov_b64 exec, -1
    s_waitcnt lgkmcnt(0)
    v_mfma_f32_32x32x16_bf16 v[32:47], v[8:11], v[4:7], v[72:87]
    s_nop 11
    v_max3_f32 v120, v32, v33, v34
    v_max3_f32 v120, v120, v35, v36
    v_max3_f32 v120, v120, v37, v38
    v_max3_f32 v120, v120, v39, v40
    v_max3_f32 v120, v120, v41, v42
    v_max3_f32 v120, v120, v43, v44
    v_max3_f32 v120, v120, v45, v46
    v_max_f32 v120, v120, v47
    v_cmp_lt_f32 vcc, s52, v120
    s_cbranch_vccnz L_rare_28
    s_nop 3
L_back_28:
    v_exp_f32 v32, v32
    v_exp_f32 v33, v33
    v_exp_f32 v34, v34
    v_exp_f32 v35, v35
    v_exp_f32 v36, v36
    v_exp_f32 v37, v37
    v_exp_f32 v38, v38
    v_exp_f32 v39, v39
    v_exp_f32 v40, v40
    v_exp_f32 v41, v41
    v_exp_f32 v42, v42
    v_exp_f32 v43, v43
    v_exp_f32 v44, v44
    v_exp_f32 v45, v45
    v_exp_f32 v46, v46
    v_exp_f32 v47, v47
    v_cvt_pk_bf16_f32 v64, v32, v33
    v_cvt_pk_bf16_f32 v65, v34, v35
    v_cvt_pk_bf16_f32 v66, v36, v37
    v_cvt_pk_bf16_f32 v67, v38, v39
    v_cvt_pk_bf16_f32 v68, v40, v41
    v_cvt_pk_bf16_f32 v69, v42, v43
    v_cvt_pk_bf16_f32 v70, v44, v45
    v_cvt_pk_bf16_f32 v71, v46, v47
    v_mfma_f32_32x32x16_bf16 v[88:103], v[16:19], v[64:67], v[88:103]
    s_nop 0
    v_mfma_f32_32x32x16_bf16 v[88:103], v[20:23], v[68:71], v[88:103]
    s_cmp_gt_u32 s37, 2
    s_cbranch_scc1 L_k2_fin
    ds_read_b128 v[8:11], v1 offset:18432
    s_mov_b64 exec, s[50:51]
    ds_read_b128 v[16:19], v2 offset:22528
    ds_read_b128 v[20:23], v2 offset:23040
    s_mov_b64 exec, -1
    s_waitcnt lgkmcnt(0)
    v_mfma_f32_32x32x16_bf16 v[32:47], v[8:11], v[4:7], v[72:87]
    s_nop 11
    v_max3_f32 v120, v32, v33, v34
    v_max3_f32 v120, v120, v35, v36
    v_max3_f32 v120, v120, v37, v38
    v_max3_f32 v120, v120, v39, v40
    v_max3_f32 v120, v120, v41, v42
    v_max3_f32 v120, v120, v43, v44
    v_max3_f32 v120, v120, v45, v46
    v_max_f32 v120, v120, v47
    v_cmp_lt_f32 vcc, s52, v120
    s_cbranch_vccnz L_rare_29
    s_nop 3
L_back_29:
    v_exp_f32 v32, v32
    v_exp_f32 v33, v33
    v_exp_f32 v34, v34
    v_exp_f32 v35, v35
    v_exp_f32 v36, v36
    v_exp_f32 v37, v37
    v_exp_f32 v38, v38
    v_exp_f32 v39, v39
    v_exp_f32 v40, v40
    v_exp_f32 v41, v41
    v_exp_f32 v42, v42
    v_exp_f32 v43, v43
    v_exp_f32 v44, v44
    v_exp_f32 v45, v45
    v_exp_f32 v46, v46
    v_exp_f32 v47, v47
    v_cvt_pk_bf16_f32 v64, v32, v33
    v_cvt_pk_bf16_f32 v65, v34, v35
    v_cvt_pk_bf16_f32 v66, v36, v37
    v_cvt_pk_bf16_f32 v67, v38, v39
    v_cvt_pk_bf16_f32 v68, v40, v41
    v_cvt_pk_bf16_f32 v69, v42, v43
    v_cvt_pk_bf16_f32 v70, v44, v45
    v_cvt_pk_bf16_f32 v71, v46, v47
    v_mfma_f32_32x32x16_bf16 v[88:103], v[16:19], v[64:67], v[88:103]
    s_nop 0
    v_mfma_f32_32x32x16_bf16 v[88:103], v[20:23], v[68:71], v[88:103]
    s_cmp_gt_u32 s37, 1
    s_cbranch_scc1 L_k2_fin
    ds_read_b128 v[8:11], v1 offset:17408
    s_mov_b64 exec, s[50:51]
    ds_read_b128 v[16:19], v2 offset:21504
    ds_read_b128 v[20:23], v2 offset:22016
    s_mov_b64 exec, -1
    s_waitcnt lgkmcnt(0)
    v_cmp_le_i32 vcc, 0, v3
    s_nop 1
    v_cndmask_b32 v104, v72, v127, vcc
    v_cmp_le_i32 vcc, 1, v3
    s_nop 1
    v_cndmask_b32 v105, v73, v127, vcc
    v_cmp_le_i32 vcc, 2, v3
    s_nop 1
    v_cndmask_b32 v106, v74, v127, vcc
    v_cmp_le_i32 vcc, 3, v3
    s_nop 1
    v_cndmask_b32 v107, v75, v127, vcc
    v_cmp_le_i32 vcc, 8, v3
    s_nop 1
    v_cndmask_b32 v108, v76, v127, vcc
    v_cmp_le_i32 vcc, 9, v3
    s_nop 1
    v_cndmask_b32 v109, v77, v127, vcc
    v_cmp_le_i32 vcc, 10, v3
    s_nop 1
    v_cndmask_b32 v110, v78, v127, vcc
    v_cmp_le_i32 vcc, 11, v3
    s_nop 1
    v_cndmask_b32 v111, v79, v127, vcc
    v_cmp_le_i32 vcc, 16, v3
    s_nop 1
    v_cndmask_b32 v112, v80, v127, vcc
    v_cmp_le_i32 vcc, 17, v3
    s_nop 1
    v_cndmask_b32 v113, v81, v127, vcc
    v_cmp_le_i32 vcc, 18, v3
    s_nop 1
    v_cndmask_b32 v114, v82, v127, vcc
    v_cmp_le_i32 vcc, 19, v3
    s_nop 1
    v_cndmask_b32 v115, v83, v127, vcc
    v_cmp_le_i32 vcc, 24, v3
    s_nop 1
    v_cndmask_b32 v116, v84, v127, vcc
    v_cmp_le_i32 vcc, 25, v3
    s_nop 1
    v_cndmask_b32 v117, v85, v127, vcc
    v_cmp_le_i32 vcc, 26, v3
    s_nop 1
    v_cndmask_b32 v118, v86, v127, vcc
    v_cmp_le_i32 vcc, 27, v3
    s_nop 1
    v_cndmask_b32 v119, v87, v127, vcc
    s_nop 1
    v_mfma_f32_32x32x16_bf16 v[32:47], v[8:11], v[4:7], v[104:119]
    s_nop 11
    v_max3_f32 v120, v32, v33, v34
    v_max3_f32 v120, v120, v35, v36
    v_max3_f32 v120, v120, v37, v38
    v_max3_f32 v120, v120, v39, v40
    v_max3_f32 v120, v120, v41, v42
    v_max3_f32 v120, v120, v43, v44
    v_max3_f32 v120, v120, v45, v46
    v_max_f32 v120, v120, v47
    v_cmp_lt_f32 vcc, s52, v120
    s_cbranch_vccnz L_rare_30
    s_nop 3
L_back_30:
    v_exp_f32 v32, v32
    v_exp_f32 v33, v33
    v_exp_f32 v34, v34
    v_exp_f32 v35, v35
    v_exp_f32 v36, v36
    v_exp_f32 v37, v37
    v_exp_f32 v38, v38
    v_exp_f32 v39, v39
    v_exp_f32 v40, v40
    v_exp_f32 v41, v41
    v_exp_f32 v42, v42
    v_exp_f32 v43, v43
    v_exp_f32 v44, v44
    v_exp_f32 v45, v45
    v_exp_f32 v46, v46
    v_exp_f32 v47, v47
    v_cvt_pk_bf16_f32 v64, v32, v33
    v_cvt_pk_bf16_f32 v65, v34, v35
    v_cvt_pk_bf16_f32 v66, v36, v37
    v_cvt_pk_bf16_f32 v67, v38, v39
    v_cvt_pk_bf16_f32 v68, v40, v41
    v_cvt_pk_bf16_f32 v69, v42, v43
    v_cvt_pk_bf16_f32 v70, v44, v45
    v_cvt_pk_bf16_f32 v71, v46, v47
    v_mfma_f32_32x32x16_bf16 v[88:103], v[16:19], v[64:67], v[88:103]
    s_nop 0
    v_mfma_f32_32x32x16_bf16 v[88:103], v[20:23], v[68:71], v[88:103]
    s_branch L_k2_fin
    s_nop 10
L_A_w2:
    s_cmp_eq_u32 s30, 2
    s_cbranch_scc0 L_A_w3
    ds_read_b128 v[8:11], v1 offset:2048
    s_mov_b64 exec, s[50:51]
    ds_read_b128 v[16:19], v2 offset:6144
    ds_read_b128 v[20:23], v2 offset:6656
    s_mov_b64 exec, -1
    s_waitcnt lgkmcnt(0)
    v_cmp_gt_i32 vcc, 0, v3
    s_nop 1
    v_cndmask_b32 v104, v72, v127, vcc
    v_cmp_gt_i32 vcc, 1, v3
    s_nop 1
    v_cndmask_b32 v105, v73, v127, vcc
    v_cmp_gt_i32 vcc, 2, v3
    s_nop 1
    v_cndmask_b32 v106, v74, v127, vcc
    v_cmp_gt_i32 vcc, 3, v3
    s_nop 1
    v_cndmask_b32 v107, v75, v127, vcc
    v_cmp_gt_i32 vcc, 8, v3
    s_nop 1
    v_cndmask_b32 v108, v76, v127, vcc
    v_cmp_gt_i32 vcc, 9, v3
    s_nop 1
    v_cndmask_b32 v109, v77, v127, vcc
    v_cmp_gt_i32 vcc, 10, v3
    s_nop 1
    v_cndmask_b32 v110, v78, v127, vcc
    v_cmp_gt_i32 vcc, 11, v3
    s_nop 1
    v_cndmask_b32 v111, v79, v127, vcc
    v_cmp_gt_i32 vcc, 16, v3
    s_nop 1
    v_cndmask_b32 v112, v80, v127, vcc
    v_cmp_gt_i32 vcc, 17, v3
    s_nop 1
    v_cndmask_b32 v113, v81, v127, vcc
    v_cmp_gt_i32 vcc, 18, v3
    s_nop 1
    v_cndmask_b32 v114, v82, v127, vcc
    v_cmp_gt_i32 vcc, 19, v3
    s_nop 1
    v_cndmask_b32 v115, v83, v127, vcc
    v_cmp_gt_i32 vcc, 24, v3
    s_nop 1
    v_cndmask_b32 v116, v84, v127, vcc
    v_cmp_gt_i32 vcc, 25, v3
    s_nop 1
    v_cndmask_b32 v117, v85, v127, vcc
    v_cmp_gt_i32 vcc, 26, v3
    s_nop 1
    v_cndmask_b32 v118, v86, v127, vcc
    v_cmp_gt_i32 vcc, 27, v3
    s_nop 1
    v_cndmask_b32 v119, v87, v127, vcc
    s_nop 1
    v_mfma_f32_32x32x16_bf16 v[32:47], v[8:11], v[4:7], v[104:119]
    s_nop 11
    v_max3_f32 v120, v32, v33, v34
    v_max3_f32 v120, v120, v35, v36
    v_max3_f32 v120, v120, v37, v38
    v_max3_f32 v120, v120, v39, v40
    v_max3_f32 v120, v120, v41, v42
    v_max3_f32 v120, v120, v43, v44
    v_max3_f32 v120, v120, v45, v46
    v_max_f32 v120, v120, v47
    v_mov_b32 v121, v120
    s_nop 1
    v_permlane32_swap_b32 v121, v120
    v_max_f32 v120, v120, v121
    v_sub_f32 v32, v32, v120
    v_sub_f32 v33, v33, v120
    v_sub_f32 v34, v34, v120
    v_sub_f32 v35, v35, v120
    v_sub_f32 v36, v36, v120
    v_sub_f32 v37, v37, v120
    v_sub_f32 v38, v38, v120
    v_sub_f32 v39, v39, v120
    v_sub_f32 v40, v40, v120
    v_sub_f32 v41, v41, v120
    v_sub_f32 v42, v42, v120
    v_sub_f32 v43, v43, v120
    v_sub_f32 v44, v44, v120
    v_sub_f32 v45, v45, v120
    v_sub_f32 v46, v46, v120
    v_sub_f32 v47, v47, v120
    v_sub_f32 v72, v72, v120
    v_sub_f32 v73, v73, v120
    v_sub_f32 v74, v74, v120
    v_sub_f32 v75, v75, v120
    v_sub_f32 v76, v76, v120
    v_sub_f32 v77, v77, v120
    v_sub_f32 v78, v78, v120
    v_sub_f32 v79, v79, v120
    v_sub_f32 v80, v80, v120
    v_sub_f32 v81, v81, v120
    v_sub_f32 v82, v82, v120
    v_sub_f32 v83, v83, v120
    v_sub_f32 v84, v84, v120
    v_sub_f32 v85, v85, v120
    v_sub_f32 v86, v86, v120
    v_sub_f32 v87, v87, v120
    v_exp_f32 v32, v32
    v_exp_f32 v33, v33
    v_exp_f32 v34, v34
    v_exp_f32 v35, v35
    v_exp_f32 v36, v36
    v_exp_f32 v37, v37
    v_exp_f32 v38, v38
    v_exp_f32 v39, v39
    v_exp_f32 v40, v40
    v_exp_f32 v41, v41
    v_exp_f32 v42, v42
    v_exp_f32 v43, v43
    v_exp_f32 v44, v44
    v_exp_f32 v45, v45
    v_exp_f32 v46, v46
    v_exp_f32 v47, v47
    v_cvt_pk_bf16_f32 v64, v32, v33
    v_cvt_pk_bf16_f32 v65, v34, v35
    v_cvt_pk_bf16_f32 v66, v36, v37
    v_cvt_pk_bf16_f32 v67, v38, v39
    v_cvt_pk_bf16_f32 v68, v40, v41
    v_cvt_pk_bf16_f32 v69, v42, v43
    v_cvt_pk_bf16_f32 v70, v44, v45
    v_cvt_pk_bf16_f32 v71, v46, v47
    v_mfma_f32_32x32x16_bf16 v[88:103], v[16:19], v[64:67], v[88:103]
    s_nop 0
    v_mfma_f32_32x32x16_bf16 v[88:103], v[20:23], v[68:71], v[88:103]
    ds_read_b128 v[8:11], v1 offset:1024
    s_mov_b64 exec, s[50:51]
    ds_read_b128 v[16:19], v2 offset:5120
    ds_read_b128 v[20:23], v2 offset:5632
    s_mov_b64 exec, -1
    s_waitcnt lgkmcnt(0)
    v_mfma_f32_32x32x16_bf16 v[32:47], v[8:11], v[4:7], v[72:87]
    s_nop 11
    v_max3_f32 v120, v32, v33, v34
    v_max3_f32 v120, v120, v35, v36
    v_max3_f32 v120, v120, v37, v38
    v_max3_f32 v120, v120, v39, v40
    v_max3_f32 v120, v120, v41, v42
    v_max3_f32 v120, v120, v43, v44
    v_max3_f32 v120, v120, v45, v46
    v_max_f32 v120, v120, v47
    v_cmp_lt_f32 vcc, s52, v120
    s_cbranch_vccnz L_rare_31
    s_nop 3
L_back_31:
    v_exp_f32 v32, v32
    v_exp_f32 v33, v33
    v_exp_f32 v34, v34
    v_exp_f32 v35, v35
    v_exp_f32 v36, v36
    v_exp_f32 v37, v37
    v_exp_f32 v38, v38
    v_exp_f32 v39, v39
    v_exp_f32 v40, v40
    v_exp_f32 v41, v41
    v_exp_f32 v42, v42
    v_exp_f32 v43, v43
    v_exp_f32 v44, v44
    v_exp_f32 v45, v45
    v_exp_f32 v46, v46
    v_exp_f32 v47, v47
    v_cvt_pk_bf16_f32 v64, v32, v33
    v_cvt_pk_bf16_f32 v65, v34, v35
    v_cvt_pk_bf16_f32 v66, v36, v37
    v_cvt_pk_bf16_f32 v67, v38, v39
    v_cvt_pk_bf16_f32 v68, v40, v41
    v_cvt_pk_bf16_f32 v69, v42, v43
    v_cvt_pk_bf16_f32 v70, v44, v45
    v_cvt_pk_bf16_f32 v71, v46, v47
    v_mfma_f32_32x32x16_bf16 v[88:103], v[16:19], v[64:67], v[88:103]
    s_nop 0
    v_mfma_f32_32x32x16_bf16 v[88:103], v[20:23], v[68:71], v[88:103]
    ds_read_b128 v[8:11], v1 offset:0
    s_mov_b64 exec, s[50:51]
    ds_read_b128 v[16:19], v2 offset:4096
    ds_read_b128 v[20:23], v2 offset:4608
    s_mov_b64 exec, -1
    s_waitcnt lgkmcnt(0)
    v_mfma_f32_32x32x16_bf16 v[32:47], v[8:11], v[4:7], v[72:87]
    s_nop 11
    v_max3_f32 v120, v32, v33, v34
    v_max3_f32 v120, v120, v35, v36
    v_max3_f32 v120, v120, v37, v38
    v_max3_f32 v120, v120, v39, v40
    v_max3_f32 v120, v120, v41, v42
    v_max3_f32 v120, v120, v43, v44
    v_max3_f32 v120, v120, v45, v46
    v_max_f32 v120, v120, v47
    v_cmp_lt_f32 vcc, s52, v120
    s_cbranch_vccnz L_rare_32
    s_nop 3
L_back_32:
    v_exp_f32 v32, v32
    v_exp_f32 v33, v33
    v_exp_f32 v34, v34
    v_exp_f32 v35, v35
    v_exp_f32 v36, v36
    v_exp_f32 v37, v37
    v_exp_f32 v38, v38
    v_exp_f32 v39, v39
    v_exp_f32 v40, v40
    v_exp_f32 v41, v41
    v_exp_f32 v42, v42
    v_exp_f32 v43, v43
    v_exp_f32 v44, v44
    v_exp_f32 v45, v45
    v_exp_f32 v46, v46
    v_exp_f32 v47, v47
    v_cvt_pk_bf16_f32 v64, v32, v33
    v_cvt_pk_bf16_f32 v65, v34, v35
    v_cvt_pk_bf16_f32 v66, v36, v37
    v_cvt_pk_bf16_f32 v67, v38, v39
    v_cvt_pk_bf16_f32 v68, v40, v41
    v_cvt_pk_bf16_f32 v69, v42, v43
    v_cvt_pk_bf16_f32 v70, v44, v45
    v_cvt_pk_bf16_f32 v71, v46, v47
    v_mfma_f32_32x32x16_bf16 v[88:103], v[16:19], v[64:67], v[88:103]
    s_nop 0
    v_mfma_f32_32x32x16_bf16 v[88:103], v[20:23], v[68:71], v[88:103]
    s_cmp_gt_u32 s37, 7
    s_cbranch_scc1 L_k2_fin
    ds_read_b128 v[8:11], v1 offset:11264
    s_mov_b64 exec, s[50:51]
    ds_read_b128 v[16:19], v2 offset:15360
    ds_read_b128 v[20:23], v2 offset:15872
    s_mov_b64 exec, -1
    s_waitcnt lgkmcnt(0)
    v_mfma_f32_32x32x16_bf16 v[32:47], v[8:11], v[4:7], v[72:87]
    s_nop 11
    v_max3_f32 v120, v32, v33, v34
    v_max3_f32 v120, v120, v35, v36
    v_max3_f32 v120, v120, v37, v38
    v_max3_f32 v120, v120, v39, v40
    v_max3_f32 v120, v120, v41, v42
    v_max3_f32 v120, v120, v43, v44
    v_max3_f32 v120, v120, v45, v46
    v_max_f32 v120, v120, v47
    v_cmp_lt_f32 vcc, s52, v120
    s_cbranch_vccnz L_rare_33
    s_nop 3
L_back_33:
    v_exp_f32 v32, v32
    v_exp_f32 v33, v33
    v_exp_f32 v34, v34
    v_exp_f32 v35, v35
    v_exp_f32 v36, v36
    v_exp_f32 v37, v37
    v_exp_f32 v38, v38
    v_exp_f32 v39, v39
    v_exp_f32 v40, v40
    v_exp_f32 v41, v41
    v_exp_f32 v42, v42
    v_exp_f32 v43, v43
    v_exp_f32 v44, v44
    v_exp_f32 v45, v45
    v_exp_f32 v46, v46
    v_exp_f32 v47, v47
    v_cvt_pk_bf16_f32 v64, v32, v33
    v_cvt_pk_bf16_f32 v65, v34, v35
    v_cvt_pk_bf16_f32 v66, v36, v37
    v_cvt_pk_bf16_f32 v67, v38, v39
    v_cvt_pk_bf16_f32 v68, v40, v41
    v_cvt_pk_bf16_f32 v69, v42, v43
    v_cvt_pk_bf16_f32 v70, v44, v45
    v_cvt_pk_bf16_f32 v71, v46, v47
    v_mfma_f32_32x32x16_bf16 v[88:103], v[16:19], v[64:67], v[88:103]
    s_nop 0
    v_mfma_f32_32x32x16_bf16 v[88:103], v[20:23], v[68:71], v[88:103]
    s_cmp_gt_u32 s37, 6
    s_cbranch_scc1 L_k2_fin
    ds_read_b128 v[8:11], v1 offset:10240
    s_mov_b64 exec, s[50:51]
    ds_read_b128 v[16:19], v2 offset:14336
    ds_read_b128 v[20:23], v2 offset:14848
    s_mov_b64 exec, -1
    s_waitcnt lgkmcnt(0)
    v_mfma_f32_32x32x16_bf16 v[32:47], v[8:11], v[4:7], v[72:87]
    s_nop 11
    v_max3_f32 v120, v32, v33, v34
    v_max3_f32 v120, v120, v35, v36
    v_max3_f32 v120, v120, v37, v38
    v_max3_f32 v120, v120, v39, v40
    v_max3_f32 v120, v120, v41, v42
    v_max3_f32 v120, v120, v43, v44
    v_max3_f32 v120, v120, v45, v46
    v_max_f32 v120, v120, v47
    v_cmp_lt_f32 vcc, s52, v120
    s_cbranch_vccnz L_rare_34
    s_nop 3
L_back_34:
    v_exp_f32 v32, v32
    v_exp_f32 v33, v33
    v_exp_f32 v34, v34
    v_exp_f32 v35, v35
    v_exp_f32 v36, v36
    v_exp_f32 v37, v37
    v_exp_f32 v38, v38
    v_exp_f32 v39, v39
    v_exp_f32 v40, v40
    v_exp_f32 v41, v41
    v_exp_f32 v42, v42
    v_exp_f32 v43, v43
    v_exp_f32 v44, v44
    v_exp_f32 v45, v45
    v_exp_f32 v46, v46
    v_exp_f32 v47, v47
    v_cvt_pk_bf16_f32 v64, v32, v33
    v_cvt_pk_bf16_f32 v65, v34, v35
    v_cvt_pk_bf16_f32 v66, v36, v37
    v_cvt_pk_bf16_f32 v67, v38, v39
    v_cvt_pk_bf16_f32 v68, v40, v41
    v_cvt_pk_bf16_f32 v69, v42, v43
    v_cvt_pk_bf16_f32 v70, v44, v45
    v_cvt_pk_bf16_f32 v71, v46, v47
    v_mfma_f32_32x32x16_bf16 v[88:103], v[16:19], v[64:67], v[88:103]
    s_nop 0
    v_mfma_f32_32x32x16_bf16 v[88:103], v[20:23], v[68:71], v[88:103]
    s_cmp_gt_u32 s37, 5
    s_cbranch_scc1 L_k2_fin
    ds_read_b128 v[8:11], v1 offset:9216
    s_mov_b64 exec, s[50:51]
    ds_read_b128 v[16:19], v2 offset:13312
    ds_read_b128 v[20:23], v2 offset:13824
    s_mov_b64 exec, -1
    s_waitcnt lgkmcnt(0)
    v_mfma_f32_32x32x16_bf16 v[32:47], v[8:11], v[4:7], v[72:87]
    s_nop 11
    v_max3_f32 v120, v32, v33, v34
    v_max3_f32 v120, v120, v35, v36
    v_max3_f32 v120, v120, v37, v38
    v_max3_f32 v120, v120, v39, v40
    v_max3_f32 v120, v120, v41, v42
    v_max3_f32 v120, v120, v43, v44
    v_max3_f32 v120, v120, v45, v46
    v_max_f32 v120, v120, v47
    v_cmp_lt_f32 vcc, s52, v120
    s_cbranch_vccnz L_rare_35
    s_nop 3
L_back_35:
    v_exp_f32 v32, v32
    v_exp_f32 v33, v33
    v_exp_f32 v34, v34
    v_exp_f32 v35, v35
    v_exp_f32 v36, v36
    v_exp_f32 v37, v37
    v_exp_f32 v38, v38
    v_exp_f32 v39, v39
    v_exp_f32 v40, v40
    v_exp_f32 v41, v41
    v_exp_f32 v42, v42
    v_exp_f32 v43, v43
    v_exp_f32 v44, v44
    v_exp_f32 v45, v45
    v_exp_f32 v46, v46
    v_exp_f32 v47, v47
    v_cvt_pk_bf16_f32 v64, v32, v33
    v_cvt_pk_bf16_f32 v65, v34, v35
    v_cvt_pk_bf16_f32 v66, v36, v37
    v_cvt_pk_bf16_f32 v67, v38, v39
    v_cvt_pk_bf16_f32 v68, v40, v41
    v_cvt_pk_bf16_f32 v69, v42, v43
    v_cvt_pk_bf16_f32 v70, v44, v45
    v_cvt_pk_bf16_f32 v71, v46, v47
    v_mfma_f32_32x32x16_bf16 v[88:103], v[16:19], v[64:67], v[88:103]
    s_nop 0
    v_mfma_f32_32x32x16_bf16 v[88:103], v[20:23], v[68:71], v[88:103]
    s_cmp_gt_u32 s37, 4
    s_cbranch_scc1 L_k2_fin
    ds_read_b128 v[8:11], v1 offset:8192
    s_mov_b64 exec, s[50:51]
    ds_read_b128 v[16:19], v2 offset:12288
    ds_read_b128 v[20:23], v2 offset:12800
    s_mov_b64 exec, -1
    s_waitcnt lgkmcnt(0)
    v_mfma_f32_32x32x16_bf16 v[32:47], v[8:11], v[4:7], v[72:87]
    s_nop 11
    v_max3_f32 v120, v32, v33, v34
    v_max3_f32 v120, v120, v35, v36
    v_max3_f32 v120, v120, v37, v38
    v_max3_f32 v120, v120, v39, v40
    v_max3_f32 v120, v120, v41, v42
    v_max3_f32 v120, v120, v43, v44
    v_max3_f32 v120, v120, v45, v46
    v_max_f32 v120, v120, v47
    v_cmp_lt_f32 vcc, s52, v120
    s_cbranch_vccnz L_rare_36
    s_nop 3
L_back_36:
    v_exp_f32 v32, v32
    v_exp_f32 v33, v33
    v_exp_f32 v34, v34
    v_exp_f32 v35, v35
    v_exp_f32 v36, v36
    v_exp_f32 v37, v37
    v_exp_f32 v38, v38
    v_exp_f32 v39, v39
    v_exp_f32 v40, v40
    v_exp_f32 v41, v41
    v_exp_f32 v42, v42
    v_exp_f32 v43, v43
    v_exp_f32 v44, v44
    v_exp_f32 v45, v45
    v_exp_f32 v46, v46
    v_exp_f32 v47, v47
    v_cvt_pk_bf16_f32 v64, v32, v33
    v_cvt_pk_bf16_f32 v65, v34, v35
    v_cvt_pk_bf16_f32 v66, v36, v37
    v_cvt_pk_bf16_f32 v67, v38, v39
    v_cvt_pk_bf16_f32 v68, v40, v41
    v_cvt_pk_bf16_f32 v69, v42, v43
    v_cvt_pk_bf16_f32 v70, v44, v45
    v_cvt_pk_bf16_f32 v71, v46, v47
    v_mfma_f32_32x32x16_bf16 v[88:103], v[16:19], v[64:67], v[88:103]
    s_nop 0
    v_mfma_f32_32x32x16_bf16 v[88:103], v[20:23], v[68:71], v[88:103]
    s_cmp_gt_u32 s37, 3
    s_cbranch_scc1 L_k2_fin
    ds_read_b128 v[8:11], v1 offset:19456
    s_mov_b64 exec, s[50:51]
    ds_read_b128 v[16:19], v2 offset:23552
    ds_read_b128 v[20:23], v2 offset:24064
    s_mov_b64 exec, -1
    s_waitcnt lgkmcnt(0)
    v_mfma_f32_32x32x16_bf16 v[32:47], v[8:11], v[4:7], v[72:87]
    s_nop 11
    v_max3_f32 v120, v32, v33, v34
    v_max3_f32 v120, v120, v35, v36
    v_max3_f32 v120, v120, v37, v38
    v_max3_f32 v120, v120, v39, v40
    v_max3_f32 v120, v120, v41, v42
    v_max3_f32 v120, v120, v43, v44
    v_max3_f32 v120, v120, v45, v46
    v_max_f32 v120, v120, v47
    v_cmp_lt_f32 vcc, s52, v120
    s_cbranch_vccnz L_rare_37
    s_nop 3
L_back_37:
    v_exp_f32 v32, v32
    v_exp_f32 v33, v33
    v_exp_f32 v34, v34
    v_exp_f32 v35, v35
    v_exp_f32 v36, v36
    v_exp_f32 v37, v37
    v_exp_f32 v38, v38
    v_exp_f32 v39, v39
    v_exp_f32 v40, v40
    v_exp_f32 v41, v41
    v_exp_f32 v42, v42
    v_exp_f32 v43, v43
    v_exp_f32 v44, v44
    v_exp_f32 v45, v45
    v_exp_f32 v46, v46
    v_exp_f32 v47, v47
    v_cvt_pk_bf16_f32 v64, v32, v33
    v_cvt_pk_bf16_f32 v65, v34, v35
    v_cvt_pk_bf16_f32 v66, v36, v37
    v_cvt_pk_bf16_f32 v67, v38, v39
    v_cvt_pk_bf16_f32 v68, v40, v41
    v_cvt_pk_bf16_f32 v69, v42, v43
    v_cvt_pk_bf16_f32 v70, v44, v45
    v_cvt_pk_bf16_f32 v71, v46, v47
    v_mfma_f32_32x32x16_bf16 v[88:103], v[16:19], v[64:67], v[88:103]
    s_nop 0
    v_mfma_f32_32x32x16_bf16 v[88:103], v[20:23], v[68:71], v[88:103]
    s_cmp_gt_u32 s37, 2
    s_cbranch_scc1 L_k2_fin
    ds_read_b128 v[8:11], v1 offset:18432
    s_mov_b64 exec, s[50:51]
    ds_read_b128 v[16:19], v2 offset:22528
    ds_read_b128 v[20:23], v2 offset:23040
    s_mov_b64 exec, -1
    s_waitcnt lgkmcnt(0)
    v_cmp_le_i32 vcc, 0, v3
    s_nop 1
    v_cndmask_b32 v104, v72, v127, vcc
    v_cmp_le_i32 vcc, 1, v3
    s_nop 1
    v_cndmask_b32 v105, v73, v127, vcc
    v_cmp_le_i32 vcc, 2, v3
    s_nop 1
    v_cndmask_b32 v106, v74, v127, vcc
    v_cmp_le_i32 vcc, 3, v3
    s_nop 1
    v_cndmask_b32 v107, v75, v127, vcc
    v_cmp_le_i32 vcc, 8, v3
    s_nop 1
    v_cndmask_b32 v108, v76, v127, vcc
    v_cmp_le_i32 vcc, 9, v3
    s_nop 1
    v_cndmask_b32 v109, v77, v127, vcc
    v_cmp_le_i32 vcc, 10, v3
    s_nop 1
    v_cndmask_b32 v110, v78, v127, vcc
    v_cmp_le_i32 vcc, 11, v3
    s_nop 1
    v_cndmask_b32 v111, v79, v127, vcc
    v_cmp_le_i32 vcc, 16, v3
    s_nop 1
    v_cndmask_b32 v112, v80, v127, vcc
    v_cmp_le_i32 vcc, 17, v3
    s_nop 1
    v_cndmask_b32 v113, v81, v127, vcc
    v_cmp_le_i32 vcc, 18, v3
    s_nop 1
    v_cndmask_b32 v114, v82, v127, vcc
    v_cmp_le_i32 vcc, 19, v3
    s_nop 1
    v_cndmask_b32 v115, v83, v127, vcc
    v_cmp_le_i32 vcc, 24, v3
    s_nop 1
    v_cndmask_b32 v116, v84, v127, vcc
    v_cmp_le_i32 vcc, 25, v3
    s_nop 1
    v_cndmask_b32 v117, v85, v127, vcc
    v_cmp_le_i32 vcc, 26, v3
    s_nop 1
    v_cndmask_b32 v118, v86, v127, vcc
    v_cmp_le_i32 vcc, 27, v3
    s_nop 1
    v_cndmask_b32 v119, v87, v127, vcc
    s_nop 1
    v_mfma_f32_32x32x16_bf16 v[32:47], v[8:11], v[4:7], v[104:119]
    s_nop 11
    v_max3_f32 v120, v32, v33, v34
    v_max3_f32 v120, v120, v35, v36
    v_max3_f32 v120, v120, v37, v38
    v_max3_f32 v120, v120, v39, v40
    v_max3_f32 v120, v120, v41, v42
    v_max3_f32 v120, v120, v43, v44
    v_max3_f32 v120, v120, v45, v46
    v_max_f32 v120, v120, v47
    v_cmp_lt_f32 vcc, s52, v120
    s_cbranch_vccnz L_rare_38
    s_nop 3
L_back_38:
    v_exp_f32 v32, v32
    v_exp_f32 v33, v33
    v_exp_f32 v34, v34
    v_exp_f32 v35, v35
    v_exp_f32 v36, v36
    v_exp_f32 v37, v37
    v_exp_f32 v38, v38
    v_exp_f32 v39, v39
    v_exp_f32 v40, v40
    v_exp_f32 v41, v41
    v_exp_f32 v42, v42
    v_exp_f32 v43, v43
    v_exp_f32 v44, v44
    v_exp_f32 v45, v45
    v_exp_f32 v46, v46
    v_exp_f32 v47, v47
    v_cvt_pk_bf16_f32 v64, v32, v33
    v_cvt_pk_bf16_f32 v65, v34, v35
    v_cvt_pk_bf16_f32 v66, v36, v37
    v_cvt_pk_bf16_f32 v67, v38, v39
    v_cvt_pk_bf16_f32 v68, v40, v41
    v_cvt_pk_bf16_f32 v69, v42, v43
    v_cvt_pk_bf16_f32 v70, v44, v45
    v_cvt_pk_bf16_f32 v71, v46, v47
    v_mfma_f32_32x32x16_bf16 v[88:103], v[16:19], v[64:67], v[88:103]
    s_nop 0
    v_mfma_f32_32x32x16_bf16 v[88:103], v[20:23], v[68:71], v[88:103]
    s_branch L_k2_fin
    s_nop 10
L_A_w3:
    ds_read_b128 v[8:11], v1 offset:3072
    s_mov_b64 exec, s[50:51]
    ds_read_b128 v[16:19], v2 offset:7168
    ds_read_b128 v[20:23], v2 offset:7680
    s_mov_b64 exec, -1
    s_waitcnt lgkmcnt(0)
    v_cmp_gt_i32 vcc, 0, v3
    s_nop 1
    v_cndmask_b32 v104, v72, v127, vcc
    v_cmp_gt_i32 vcc, 1, v3
    s_nop 1
    v_cndmask_b32 v105, v73, v127, vcc
    v_cmp_gt_i32 vcc, 2, v3
    s_nop 1
    v_cndmask_b32 v106, v74, v127, vcc
    v_cmp_gt_i32 vcc, 3, v3
    s_nop 1
    v_cndmask_b32 v107, v75, v127, vcc
    v_cmp_gt_i32 vcc, 8, v3
    s_nop 1
    v_cndmask_b32 v108, v76, v127, vcc
    v_cmp_gt_i32 vcc, 9, v3
    s_nop 1
    v_cndmask_b32 v109, v77, v127, vcc
    v_cmp_gt_i32 vcc, 10, v3
    s_nop 1
    v_cndmask_b32 v110, v78, v127, vcc
    v_cmp_gt_i32 vcc, 11, v3
    s_nop 1
    v_cndmask_b32 v111, v79, v127, vcc
    v_cmp_gt_i32 vcc, 16, v3
    s_nop 1
    v_cndmask_b32 v112, v80, v127, vcc
    v_cmp_gt_i32 vcc, 17, v3
    s_nop 1
    v_cndmask_b32 v113, v81, v127, vcc
    v_cmp_gt_i32 vcc, 18, v3
    s_nop 1
    v_cndmask_b32 v114, v82, v127, vcc
    v_cmp_gt_i32 vcc, 19, v3
    s_nop 1
    v_cndmask_b32 v115, v83, v127, vcc
    v_cmp_gt_i32 vcc, 24, v3
    s_nop 1
    v_cndmask_b32 v116, v84, v127, vcc
    v_cmp_gt_i32 vcc, 25, v3
    s_nop 1
    v_cndmask_b32 v117, v85, v127, vcc
    v_cmp_gt_i32 vcc, 26, v3
    s_nop 1
    v_cndmask_b32 v118, v86, v127, vcc
    v_cmp_gt_i32 vcc, 27, v3
    s_nop 1
    v_cndmask_b32 v119, v87, v127, vcc
    s_nop 1
    v_mfma_f32_32x32x16_bf16 v[32:47], v[8:11], v[4:7], v[104:119]
    s_nop 11
    v_max3_f32 v120, v32, v33, v34
    v_max3_f32 v120, v120, v35, v36
    v_max3_f32 v120, v120, v37, v38
    v_max3_f32 v120, v120, v39, v40
    v_max3_f32 v120, v120, v41, v42
    v_max3_f32 v120, v120, v43, v44
    v_max3_f32 v120, v120, v45, v46
    v_max_f32 v120, v120, v47
    v_mov_b32 v121, v120
    s_nop 1
    v_permlane32_swap_b32 v121, v120
    v_max_f32 v120, v120, v121
    v_sub_f32 v32, v32, v120
    v_sub_f32 v33, v33, v120
    v_sub_f32 v34, v34, v120
    v_sub_f32 v35, v35, v120
    v_sub_f32 v36, v36, v120
    v_sub_f32 v37, v37, v120
    v_sub_f32 v38, v38, v120
    v_sub_f32 v39, v39, v120
    v_sub_f32 v40, v40, v120
    v_sub_f32 v41, v41, v120
    v_sub_f32 v42, v42, v120
    v_sub_f32 v43, v43, v120
    v_sub_f32 v44, v44, v120
    v_sub_f32 v45, v45, v120
    v_sub_f32 v46, v46, v120
    v_sub_f32 v47, v47, v120
    v_sub_f32 v72, v72, v120
    v_sub_f32 v73, v73, v120
    v_sub_f32 v74, v74, v120
    v_sub_f32 v75, v75, v120
    v_sub_f32 v76, v76, v120
    v_sub_f32 v77, v77, v120
    v_sub_f32 v78, v78, v120
    v_sub_f32 v79, v79, v120
    v_sub_f32 v80, v80, v120
    v_sub_f32 v81, v81, v120
    v_sub_f32 v82, v82, v120
    v_sub_f32 v83, v83, v120
    v_sub_f32 v84, v84, v120
    v_sub_f32 v85, v85, v120
    v_sub_f32 v86, v86, v120
    v_sub_f32 v87, v87, v120
    v_exp_f32 v32, v32
    v_exp_f32 v33, v33
    v_exp_f32 v34, v34
    v_exp_f32 v35, v35
    v_exp_f32 v36, v36
    v_exp_f32 v37, v37
    v_exp_f32 v38, v38
    v_exp_f32 v39, v39
    v_exp_f32 v40, v40
    v_exp_f32 v41, v41
    v_exp_f32 v42, v42
    v_exp_f32 v43, v43
    v_exp_f32 v44, v44
    v_exp_f32 v45, v45
    v_exp_f32 v46, v46
    v_exp_f32 v47, v47
    v_cvt_pk_bf16_f32 v64, v32, v33
    v_cvt_pk_bf16_f32 v65, v34, v35
    v_cvt_pk_bf16_f32 v66, v36, v37
    v_cvt_pk_bf16_f32 v67, v38, v39
    v_cvt_pk_bf16_f32 v68, v40, v41
    v_cvt_pk_bf16_f32 v69, v42, v43
    v_cvt_pk_bf16_f32 v70, v44, v45
    v_cvt_pk_bf16_f32 v71, v46, v47
    v_mfma_f32_32x32x16_bf16 v[88:103], v[16:19], v[64:67], v[88:103]
    s_nop 0
    v_mfma_f32_32x32x16_bf16 v[88:103], v[20:23], v[68:71], v[88:103]
    ds_read_b128 v[8:11], v1 offset:2048
    s_mov_b64 exec, s[50:51]
    ds_read_b128 v[16:19], v2 offset:6144
    ds_read_b128 v[20:23], v2 offset:6656
    s_mov_b64 exec, -1
    s_waitcnt lgkmcnt(0)
    v_mfma_f32_32x32x16_bf16 v[32:47], v[8:11], v[4:7], v[72:87]
    s_nop 11
    v_max3_f32 v120, v32, v33, v34
    v_max3_f32 v120, v120, v35, v36
    v_max3_f32 v120, v120, v37, v38
    v_max3_f32 v120, v120, v39, v40
    v_max3_f32 v120, v120, v41, v42
    v_max3_f32 v120, v120, v43, v44
    v_max3_f32 v120, v120, v45, v46
    v_max_f32 v120, v120, v47
    v_cmp_lt_f32 vcc, s52, v120
    s_cbranch_vccnz L_rare_39
    s_nop 3
L_back_39:
    v_exp_f32 v32, v32
    v_exp_f32 v33, v33
    v_exp_f32 v34, v34
    v_exp_f32 v35, v35
    v_exp_f32 v36, v36
    v_exp_f32 v37, v37
    v_exp_f32 v38, v38
    v_exp_f32 v39, v39
    v_exp_f32 v40, v40
    v_exp_f32 v41, v41
    v_exp_f32 v42, v42
    v_exp_f32 v43, v43
    v_exp_f32 v44, v44
    v_exp_f32 v45, v45
    v_exp_f32 v46, v46
    v_exp_f32 v47, v47
    v_cvt_pk_bf16_f32 v64, v32, v33
    v_cvt_pk_bf16_f32 v65, v34, v35
    v_cvt_pk_bf16_f32 v66, v36, v37
    v_cvt_pk_bf16_f32 v67, v38, v39
    v_cvt_pk_bf16_f32 v68, v40, v41
    v_cvt_pk_bf16_f32 v69, v42, v43
    v_cvt_pk_bf16_f32 v70, v44, v45
    v_cvt_pk_bf16_f32 v71, v46, v47
    v_mfma_f32_32x32x16_bf16 v[88:103], v[16:19], v[64:67], v[88:103]
    s_nop 0
    v_mfma_f32_32x32x16_bf16 v[88:103], v[20:23], v[68:71], v[88:103]
    ds_read_b128 v[8:11], v1 offset:1024
    s_mov_b64 exec, s[50:51]
    ds_read_b128 v[16:19], v2 offset:5120
    ds_read_b128 v[20:23], v2 offset:5632
    s_mov_b64 exec, -1
    s_waitcnt lgkmcnt(0)
    v_mfma_f32_32x32x16_bf16 v[32:47], v[8:11], v[4:7], v[72:87]
    s_nop 11
    v_max3_f32 v120, v32, v33, v34
    v_max3_f32 v120, v120, v35, v36
    v_max3_f32 v120, v120, v37, v38
    v_max3_f32 v120, v120, v39, v40
    v_max3_f32 v120, v120, v41, v42
    v_max3_f32 v120, v120, v43, v44
    v_max3_f32 v120, v120, v45, v46
    v_max_f32 v120, v120, v47
    v_cmp_lt_f32 vcc, s52, v120
    s_cbranch_vccnz L_rare_40
    s_nop 3
L_back_40:
    v_exp_f32 v32, v32
    v_exp_f32 v33, v33
    v_exp_f32 v34, v34
    v_exp_f32 v35, v35
    v_exp_f32 v36, v36
    v_exp_f32 v37, v37
    v_exp_f32 v38, v38
    v_exp_f32 v39, v39
    v_exp_f32 v40, v40
    v_exp_f32 v41, v41
    v_exp_f32 v42, v42
    v_exp_f32 v43, v43
    v_exp_f32 v44, v44
    v_exp_f32 v45, v45
    v_exp_f32 v46, v46
    v_exp_f32 v47, v47
    v_cvt_pk_bf16_f32 v64, v32, v33
    v_cvt_pk_bf16_f32 v65, v34, v35
    v_cvt_pk_bf16_f32 v66, v36, v37
    v_cvt_pk_bf16_f32 v67, v38, v39
    v_cvt_pk_bf16_f32 v68, v40, v41
    v_cvt_pk_bf16_f32 v69, v42, v43
    v_cvt_pk_bf16_f32 v70, v44, v45
    v_cvt_pk_bf16_f32 v71, v46, v47
    v_mfma_f32_32x32x16_bf16 v[88:103], v[16:19], v[64:67], v[88:103]
    s_nop 0
    v_mfma_f32_32x32x16_bf16 v[88:103], v[20:23], v[68:71], v[88:103]
    ds_read_b128 v[8:11], v1 offset:0
    s_mov_b64 exec, s[50:51]
    ds_read_b128 v[16:19], v2 offset:4096
    ds_read_b128 v[20:23], v2 offset:4608
    s_mov_b64 exec, -1
    s_waitcnt lgkmcnt(0)
    v_mfma_f32_32x32x16_bf16 v[32:47], v[8:11], v[4:7], v[72:87]
    s_nop 11
    v_max3_f32 v120, v32, v33, v34
    v_max3_f32 v120, v120, v35, v36
    v_max3_f32 v120, v120, v37, v38
    v_max3_f32 v120, v120, v39, v40
    v_max3_f32 v120, v120, v41, v42
    v_max3_f32 v120, v120, v43, v44
    v_max3_f32 v120, v120, v45, v46
    v_max_f32 v120, v120, v47
    v_cmp_lt_f32 vcc, s52, v120
    s_cbranch_vccnz L_rare_41
    s_nop 3
L_back_41:
    v_exp_f32 v32, v32
    v_exp_f32 v33, v33
    v_exp_f32 v34, v34
    v_exp_f32 v35, v35
    v_exp_f32 v36, v36
    v_exp_f32 v37, v37
    v_exp_f32 v38, v38
    v_exp_f32 v39, v39
    v_exp_f32 v40, v40
    v_exp_f32 v41, v41
    v_exp_f32 v42, v42
    v_exp_f32 v43, v43
    v_exp_f32 v44, v44
    v_exp_f32 v45, v45
    v_exp_f32 v46, v46
    v_exp_f32 v47, v47
    v_cvt_pk_bf16_f32 v64, v32, v33
    v_cvt_pk_bf16_f32 v65, v34, v35
    v_cvt_pk_bf16_f32 v66, v36, v37
    v_cvt_pk_bf16_f32 v67, v38, v39
    v_cvt_pk_bf16_f32 v68, v40, v41
    v_cvt_pk_bf16_f32 v69, v42, v43
    v_cvt_pk_bf16_f32 v70, v44, v45
    v_cvt_pk_bf16_f32 v71, v46, v47
    v_mfma_f32_32x32x16_bf16 v[88:103], v[16:19], v[64:67], v[88:103]
    s_nop 0
    v_mfma_f32_32x32x16_bf16 v[88:103], v[20:23], v[68:71], v[88:103]
    s_cmp_gt_u32 s37, 7
    s_cbranch_scc1 L_k2_fin
    ds_read_b128 v[8:11], v1 offset:11264
    s_mov_b64 exec, s[50:51]
    ds_read_b128 v[16:19], v2 offset:15360
    ds_read_b128 v[20:23], v2 offset:15872
    s_mov_b64 exec, -1
    s_waitcnt lgkmcnt(0)
    v_mfma_f32_32x32x16_bf16 v[32:47], v[8:11], v[4:7], v[72:87]
    s_nop 11
    v_max3_f32 v120, v32, v33, v34
    v_max3_f32 v120, v120, v35, v36
    v_max3_f32 v120, v120, v37, v38
    v_max3_f32 v120, v120, v39, v40
    v_max3_f32 v120, v120, v41, v42
    v_max3_f32 v120, v120, v43, v44
    v_max3_f32 v120, v120, v45, v46
    v_max_f32 v120, v120, v47
    v_cmp_lt_f32 vcc, s52, v120
    s_cbranch_vccnz L_rare_42
    s_nop 3
L_back_42:
    v_exp_f32 v32, v32
    v_exp_f32 v33, v33
    v_exp_f32 v34, v34
    v_exp_f32 v35, v35
    v_exp_f32 v36, v36
    v_exp_f32 v37, v37
    v_exp_f32 v38, v38
    v_exp_f32 v39, v39
    v_exp_f32 v40, v40
    v_exp_f32 v41, v41
    v_exp_f32 v42, v42
    v_exp_f32 v43, v43
    v_exp_f32 v44, v44
    v_exp_f32 v45, v45
    v_exp_f32 v46, v46
    v_exp_f32 v47, v47
    v_cvt_pk_bf16_f32 v64, v32, v33
    v_cvt_pk_bf16_f32 v65, v34, v35
    v_cvt_pk_bf16_f32 v66, v36, v37
    v_cvt_pk_bf16_f32 v67, v38, v39
    v_cvt_pk_bf16_f32 v68, v40, v41
    v_cvt_pk_bf16_f32 v69, v42, v43
    v_cvt_pk_bf16_f32 v70, v44, v45
    v_cvt_pk_bf16_f32 v71, v46, v47
    v_mfma_f32_32x32x16_bf16 v[88:103], v[16:19], v[64:67], v[88:103]
    s_nop 0
    v_mfma_f32_32x32x16_bf16 v[88:103], v[20:23], v[68:71], v[88:103]
    s_cmp_gt_u32 s37, 6
    s_cbranch_scc1 L_k2_fin
    ds_read_b128 v[8:11], v1 offset:10240
    s_mov_b64 exec, s[50:51]
    ds_read_b128 v[16:19], v2 offset:14336
    ds_read_b128 v[20:23], v2 offset:14848
    s_mov_b64 exec, -1
    s_waitcnt lgkmcnt(0)
    v_mfma_f32_32x32x16_bf16 v[32:47], v[8:11], v[4:7], v[72:87]
    s_nop 11
    v_max3_f32 v120, v32, v33, v34
    v_max3_f32 v120, v120, v35, v36
    v_max3_f32 v120, v120, v37, v38
    v_max3_f32 v120, v120, v39, v40
    v_max3_f32 v120, v120, v41, v42
    v_max3_f32 v120, v120, v43, v44
    v_max3_f32 v120, v120, v45, v46
    v_max_f32 v120, v120, v47
    v_cmp_lt_f32 vcc, s52, v120
    s_cbranch_vccnz L_rare_43
    s_nop 3
L_back_43:
    v_exp_f32 v32, v32
    v_exp_f32 v33, v33
    v_exp_f32 v34, v34
    v_exp_f32 v35, v35
    v_exp_f32 v36, v36
    v_exp_f32 v37, v37
    v_exp_f32 v38, v38
    v_exp_f32 v39, v39
    v_exp_f32 v40, v40
    v_exp_f32 v41, v41
    v_exp_f32 v42, v42
    v_exp_f32 v43, v43
    v_exp_f32 v44, v44
    v_exp_f32 v45, v45
    v_exp_f32 v46, v46
    v_exp_f32 v47, v47
    v_cvt_pk_bf16_f32 v64, v32, v33
    v_cvt_pk_bf16_f32 v65, v34, v35
    v_cvt_pk_bf16_f32 v66, v36, v37
    v_cvt_pk_bf16_f32 v67, v38, v39
    v_cvt_pk_bf16_f32 v68, v40, v41
    v_cvt_pk_bf16_f32 v69, v42, v43
    v_cvt_pk_bf16_f32 v70, v44, v45
    v_cvt_pk_bf16_f32 v71, v46, v47
    v_mfma_f32_32x32x16_bf16 v[88:103], v[16:19], v[64:67], v[88:103]
    s_nop 0
    v_mfma_f32_32x32x16_bf16 v[88:103], v[20:23], v[68:71], v[88:103]
    s_cmp_gt_u32 s37, 5
    s_cbranch_scc1 L_k2_fin
    ds_read_b128 v[8:11], v1 offset:9216
    s_mov_b64 exec, s[50:51]
    ds_read_b128 v[16:19], v2 offset:13312
    ds_read_b128 v[20:23], v2 offset:13824
    s_mov_b64 exec, -1
    s_waitcnt lgkmcnt(0)
    v_mfma_f32_32x32x16_bf16 v[32:47], v[8:11], v[4:7], v[72:87]
    s_nop 11
    v_max3_f32 v120, v32, v33, v34
    v_max3_f32 v120, v120, v35, v36
    v_max3_f32 v120, v120, v37, v38
    v_max3_f32 v120, v120, v39, v40
    v_max3_f32 v120, v120, v41, v42
    v_max3_f32 v120, v120, v43, v44
    v_max3_f32 v120, v120, v45, v46
    v_max_f32 v120, v120, v47
    v_cmp_lt_f32 vcc, s52, v120
    s_cbranch_vccnz L_rare_44
    s_nop 3
L_back_44:
    v_exp_f32 v32, v32
    v_exp_f32 v33, v33
    v_exp_f32 v34, v34
    v_exp_f32 v35, v35
    v_exp_f32 v36, v36
    v_exp_f32 v37, v37
    v_exp_f32 v38, v38
    v_exp_f32 v39, v39
    v_exp_f32 v40, v40
    v_exp_f32 v41, v41
    v_exp_f32 v42, v42
    v_exp_f32 v43, v43
    v_exp_f32 v44, v44
    v_exp_f32 v45, v45
    v_exp_f32 v46, v46
    v_exp_f32 v47, v47
    v_cvt_pk_bf16_f32 v64, v32, v33
    v_cvt_pk_bf16_f32 v65, v34, v35
    v_cvt_pk_bf16_f32 v66, v36, v37
    v_cvt_pk_bf16_f32 v67, v38, v39
    v_cvt_pk_bf16_f32 v68, v40, v41
    v_cvt_pk_bf16_f32 v69, v42, v43
    v_cvt_pk_bf16_f32 v70, v44, v45
    v_cvt_pk_bf16_f32 v71, v46, v47
    v_mfma_f32_32x32x16_bf16 v[88:103], v[16:19], v[64:67], v[88:103]
    s_nop 0
    v_mfma_f32_32x32x16_bf16 v[88:103], v[20:23], v[68:71], v[88:103]
    s_cmp_gt_u32 s37, 4
    s_cbranch_scc1 L_k2_fin
    ds_read_b128 v[8:11], v1 offset:8192
    s_mov_b64 exec, s[50:51]
    ds_read_b128 v[16:19], v2 offset:12288
    ds_read_b128 v[20:23], v2 offset:12800
    s_mov_b64 exec, -1
    s_waitcnt lgkmcnt(0)
    v_mfma_f32_32x32x16_bf16 v[32:47], v[8:11], v[4:7], v[72:87]
    s_nop 11
    v_max3_f32 v120, v32, v33, v34
    v_max3_f32 v120, v120, v35, v36
    v_max3_f32 v120, v120, v37, v38
    v_max3_f32 v120, v120, v39, v40
    v_max3_f32 v120, v120, v41, v42
    v_max3_f32 v120, v120, v43, v44
    v_max3_f32 v120, v120, v45, v46
    v_max_f32 v120, v120, v47
    v_cmp_lt_f32 vcc, s52, v120
    s_cbranch_vccnz L_rare_45
    s_nop 3
L_back_45:
    v_exp_f32 v32, v32
    v_exp_f32 v33, v33
    v_exp_f32 v34, v34
    v_exp_f32 v35, v35
    v_exp_f32 v36, v36
    v_exp_f32 v37, v37
    v_exp_f32 v38, v38
    v_exp_f32 v39, v39
    v_exp_f32 v40, v40
    v_exp_f32 v41, v41
    v_exp_f32 v42, v42
    v_exp_f32 v43, v43
    v_exp_f32 v44, v44
    v_exp_f32 v45, v45
    v_exp_f32 v46, v46
    v_exp_f32 v47, v47
    v_cvt_pk_bf16_f32 v64, v32, v33
    v_cvt_pk_bf16_f32 v65, v34, v35
    v_cvt_pk_bf16_f32 v66, v36, v37
    v_cvt_pk_bf16_f32 v67, v38, v39
    v_cvt_pk_bf16_f32 v68, v40, v41
    v_cvt_pk_bf16_f32 v69, v42, v43
    v_cvt_pk_bf16_f32 v70, v44, v45
    v_cvt_pk_bf16_f32 v71, v46, v47
    v_mfma_f32_32x32x16_bf16 v[88:103], v[16:19], v[64:67], v[88:103]
    s_nop 0
    v_mfma_f32_32x32x16_bf16 v[88:103], v[20:23], v[68:71], v[88:103]
    s_cmp_gt_u32 s37, 3
    s_cbranch_scc1 L_k2_fin
    ds_read_b128 v[8:11], v1 offset:19456
    s_mov_b64 exec, s[50:51]
    ds_read_b128 v[16:19], v2 offset:23552
    ds_read_b128 v[20:23], v2 offset:24064
    s_mov_b64 exec, -1
    s_waitcnt lgkmcnt(0)
    v_cmp_le_i32 vcc, 0, v3
    s_nop 1
    v_cndmask_b32 v104, v72, v127, vcc
    v_cmp_le_i32 vcc, 1, v3
    s_nop 1
    v_cndmask_b32 v105, v73, v127, vcc
    v_cmp_le_i32 vcc, 2, v3
    s_nop 1
    v_cndmask_b32 v106, v74, v127, vcc
    v_cmp_le_i32 vcc, 3, v3
    s_nop 1
    v_cndmask_b32 v107, v75, v127, vcc
    v_cmp_le_i32 vcc, 8, v3
    s_nop 1
    v_cndmask_b32 v108, v76, v127, vcc
    v_cmp_le_i32 vcc, 9, v3
    s_nop 1
    v_cndmask_b32 v109, v77, v127, vcc
    v_cmp_le_i32 vcc, 10, v3
    s_nop 1
    v_cndmask_b32 v110, v78, v127, vcc
    v_cmp_le_i32 vcc, 11, v3
    s_nop 1
    v_cndmask_b32 v111, v79, v127, vcc
    v_cmp_le_i32 vcc, 16, v3
    s_nop 1
    v_cndmask_b32 v112, v80, v127, vcc
    v_cmp_le_i32 vcc, 17, v3
    s_nop 1
    v_cndmask_b32 v113, v81, v127, vcc
    v_cmp_le_i32 vcc, 18, v3
    s_nop 1
    v_cndmask_b32 v114, v82, v127, vcc
    v_cmp_le_i32 vcc, 19, v3
    s_nop 1
    v_cndmask_b32 v115, v83, v127, vcc
    v_cmp_le_i32 vcc, 24, v3
    s_nop 1
    v_cndmask_b32 v116, v84, v127, vcc
    v_cmp_le_i32 vcc, 25, v3
    s_nop 1
    v_cndmask_b32 v117, v85, v127, vcc
    v_cmp_le_i32 vcc, 26, v3
    s_nop 1
    v_cndmask_b32 v118, v86, v127, vcc
    v_cmp_le_i32 vcc, 27, v3
    s_nop 1
    v_cndmask_b32 v119, v87, v127, vcc
    s_nop 1
    v_mfma_f32_32x32x16_bf16 v[32:47], v[8:11], v[4:7], v[104:119]
    s_nop 11
    v_max3_f32 v120, v32, v33, v34
    v_max3_f32 v120, v120, v35, v36
    v_max3_f32 v120, v120, v37, v38
    v_max3_f32 v120, v120, v39, v40
    v_max3_f32 v120, v120, v41, v42
    v_max3_f32 v120, v120, v43, v44
    v_max3_f32 v120, v120, v45, v46
    v_max_f32 v120, v120, v47
    v_cmp_lt_f32 vcc, s52, v120
    s_cbranch_vccnz L_rare_46
    s_nop 3
L_back_46:
    v_exp_f32 v32, v32
    v_exp_f32 v33, v33
    v_exp_f32 v34, v34
    v_exp_f32 v35, v35
    v_exp_f32 v36, v36
    v_exp_f32 v37, v37
    v_exp_f32 v38, v38
    v_exp_f32 v39, v39
    v_exp_f32 v40, v40
    v_exp_f32 v41, v41
    v_exp_f32 v42, v42
    v_exp_f32 v43, v43
    v_exp_f32 v44, v44
    v_exp_f32 v45, v45
    v_exp_f32 v46, v46
    v_exp_f32 v47, v47
    v_cvt_pk_bf16_f32 v64, v32, v33
    v_cvt_pk_bf16_f32 v65, v34, v35
    v_cvt_pk_bf16_f32 v66, v36, v37
    v_cvt_pk_bf16_f32 v67, v38, v39
    v_cvt_pk_bf16_f32 v68, v40, v41
    v_cvt_pk_bf16_f32 v69, v42, v43
    v_cvt_pk_bf16_f32 v70, v44, v45
    v_cvt_pk_bf16_f32 v71, v46, v47
    v_mfma_f32_32x32x16_bf16 v[88:103], v[16:19], v[64:67], v[88:103]
    s_nop 0
    v_mfma_f32_32x32x16_bf16 v[88:103], v[20:23], v[68:71], v[88:103]
    s_branch L_k2_fin
    s_nop 10
L_k2_fin:
    s_nop 15
    v_rcp_f32 v120, v96
    s_nop 0
    v_mul_f32 v88, v88, v120
    v_mul_f32 v89, v89, v120
    v_mul_f32 v90, v90, v120
    v_mul_f32 v91, v91, v120
    v_mul_f32 v92, v92, v120
    v_mul_f32 v93, v93, v120
    v_mul_f32 v94, v94, v120
    v_mul_f32 v95, v95, v120
    v_cvt_pk_bf16_f32 v64, v88, v89
    v_cvt_pk_bf16_f32 v65, v90, v91
    v_cvt_pk_bf16_f32 v66, v92, v93
    v_cvt_pk_bf16_f32 v67, v94, v95
    v_lshlrev_b32 v124, 5, v122
    v_lshl_add_u32 v124, v123, 3, v124
    s_add_u32 s32, s32, 12582912
    buffer_store_dwordx2 v[64:65], v124, s[20:23], s32 offen
    buffer_store_dwordx2 v[66:67], v124, s[20:23], s32 offen offset:16
    s_waitcnt vmcnt(0)
    s_branch L_k2_end
L_rare_0:
    v_mov_b32 v121, v120
    s_nop 1
    v_permlane32_swap_b32 v121, v120
    v_max_f32 v120, v120, v121
    v_max_f32 v120, 0, v120
    v_sub_f32 v121, 0, v120
    v_exp_f32 v121, v121
    s_nop 0
    v_mul_f32 v88, v88, v121
    v_mul_f32 v89, v89, v121
    v_mul_f32 v90, v90, v121
    v_mul_f32 v91, v91, v121
    v_mul_f32 v92, v92, v121
    v_mul_f32 v93, v93, v121
    v_mul_f32 v94, v94, v121
    v_mul_f32 v95, v95, v121
    v_mul_f32 v96, v96, v121
    v_mul_f32 v97, v97, v121
    v_mul_f32 v98, v98, v121
    v_mul_f32 v99, v99, v121
    v_mul_f32 v100, v100, v121
    v_mul_f32 v101, v101, v121
    v_mul_f32 v102, v102, v121
    v_mul_f32 v103, v103, v121
    v_sub_f32 v48, v48, v120
    v_sub_f32 v49, v49, v120
    v_sub_f32 v50, v50, v120
    v_sub_f32 v51, v51, v120
    v_sub_f32 v52, v52, v120
    v_sub_f32 v53, v53, v120
    v_sub_f32 v54, v54, v120
    v_sub_f32 v55, v55, v120
    v_sub_f32 v56, v56, v120
    v_sub_f32 v57, v57, v120
    v_sub_f32 v58, v58, v120
    v_sub_f32 v59, v59, v120
    v_sub_f32 v60, v60, v120
    v_sub_f32 v61, v61, v120
    v_sub_f32 v62, v62, v120
    v_sub_f32 v63, v63, v120
    v_sub_f32 v72, v72, v120
    v_sub_f32 v73, v73, v120
    v_sub_f32 v74, v74, v120
    v_sub_f32 v75, v75, v120
    v_sub_f32 v76, v76, v120
    v_sub_f32 v77, v77, v120
    v_sub_f32 v78, v78, v120
    v_sub_f32 v79, v79, v120
    v_sub_f32 v80, v80, v120
    v_sub_f32 v81, v81, v120
    v_sub_f32 v82, v82, v120
    v_sub_f32 v83, v83, v120
    v_sub_f32 v84, v84, v120
    v_sub_f32 v85, v85, v120
    v_sub_f32 v86, v86, v120
    v_sub_f32 v87, v87, v120
    s_branch L_back_0
    s_nop 0
L_rare_1:
    v_mov_b32 v121, v120
    s_nop 1
    v_permlane32_swap_b32 v121, v120
    v_max_f32 v120, v120, v121
    v_max_f32 v120, 0, v120
    v_sub_f32 v121, 0, v120
    v_exp_f32 v121, v121
    s_nop 0
    v_mul_f32 v88, v88, v121
    v_mul_f32 v89, v89, v121
    v_mul_f32 v90, v90, v121
    v_mul_f32 v91, v91, v121
    v_mul_f32 v92, v92, v121
    v_mul_f32 v93, v93, v121
    v_mul_f32 v94, v94, v121
    v_mul_f32 v95, v95, v121
    v_mul_f32 v96, v96, v121
    v_mul_f32 v97, v97, v121
    v_mul_f32 v98, v98, v121
    v_mul_f32 v99, v99, v121
    v_mul_f32 v100, v100, v121
    v_mul_f32 v101, v101, v121
    v_mul_f32 v102, v102, v121
    v_mul_f32 v103, v103, v121
    v_sub_f32 v32, v32, v120
    v_sub_f32 v33, v33, v120
    v_sub_f32 v34, v34, v120
    v_sub_f32 v35, v35, v120
    v_sub_f32 v36, v36, v120
    v_sub_f32 v37, v37, v120
    v_sub_f32 v38, v38, v120
    v_sub_f32 v39, v39, v120
    v_sub_f32 v40, v40, v120
    v_sub_f32 v41, v41, v120
    v_sub_f32 v42, v42, v120
    v_sub_f32 v43, v43, v120
    v_sub_f32 v44, v44, v120
    v_sub_f32 v45, v45, v120
    v_sub_f32 v46, v46, v120
    v_sub_f32 v47, v47, v120
    v_sub_f32 v72, v72, v120
    v_sub_f32 v73, v73, v120
    v_sub_f32 v74, v74, v120
    v_sub_f32 v75, v75, v120
    v_sub_f32 v76, v76, v120
    v_sub_f32 v77, v77, v120
    v_sub_f32 v78, v78, v120
    v_sub_f32 v79, v79, v120
    v_sub_f32 v80, v80, v120
    v_sub_f32 v81, v81, v120
    v_sub_f32 v82, v82, v120
    v_sub_f32 v83, v83, v120
    v_sub_f32 v84, v84, v120
    v_sub_f32 v85, v85, v120
    v_sub_f32 v86, v86, v120
    v_sub_f32 v87, v87, v120
    s_branch L_back_1
    s_nop 0
L_rare_2:
    v_mov_b32 v121, v120
    s_nop 1
    v_permlane32_swap_b32 v121, v120
    v_max_f32 v120, v120, v121
    v_max_f32 v120, 0, v120
    v_sub_f32 v121, 0, v120
    v_exp_f32 v121, v121
    s_nop 0
    v_mul_f32 v88, v88, v121
    v_mul_f32 v89, v89, v121
    v_mul_f32 v90, v90, v121
    v_mul_f32 v91, v91, v121
    v_mul_f32 v92, v92, v121
    v_mul_f32 v93, v93, v121
    v_mul_f32 v94, v94, v121
    v_mul_f32 v95, v95, v121
    v_mul_f32 v96, v96, v121
    v_mul_f32 v97, v97, v121
    v_mul_f32 v98, v98, v121
    v_mul_f32 v99, v99, v121
    v_mul_f32 v100, v100, v121
    v_mul_f32 v101, v101, v121
    v_mul_f32 v102, v102, v121
    v_mul_f32 v103, v103, v121
    v_sub_f32 v48, v48, v120
    v_sub_f32 v49, v49, v120
    v_sub_f32 v50, v50, v120
    v_sub_f32 v51, v51, v120
    v_sub_f32 v52, v52, v120
    v_sub_f32 v53, v53, v120
    v_sub_f32 v54, v54, v120
    v_sub_f32 v55, v55, v120
    v_sub_f32 v56, v56, v120
    v_sub_f32 v57, v57, v120
    v_sub_f32 v58, v58, v120
    v_sub_f32 v59, v59, v120
    v_sub_f32 v60, v60, v120
    v_sub_f32 v61, v61, v120
    v_sub_f32 v62, v62, v120
    v_sub_f32 v63, v63, v120
    v_sub_f32 v72, v72, v120
    v_sub_f32 v73, v73, v120
    v_sub_f32 v74, v74, v120
    v_sub_f32 v75, v75, v120
    v_sub_f32 v76, v76, v120
    v_sub_f32 v77, v77, v120
    v_sub_f32 v78, v78, v120
    v_sub_f32 v79, v79, v120
    v_sub_f32 v80, v80, v120
    v_sub_f32 v81, v81, v120
    v_sub_f32 v82, v82, v120
    v_sub_f32 v83, v83, v120
    v_sub_f32 v84, v84, v120
    v_sub_f32 v85, v85, v120
    v_sub_f32 v86, v86, v120
    v_sub_f32 v87, v87, v120
    s_branch L_back_2
    s_nop 0
L_rare_3:
    v_mov_b32 v121, v120
    s_nop 1
    v_permlane32_swap_b32 v121, v120
    v_max_f32 v120, v120, v121
    v_max_f32 v120, 0, v120
    v_sub_f32 v121, 0, v120
    v_exp_f32 v121, v121
    s_nop 0
    v_mul_f32 v88, v88, v121
    v_mul_f32 v89, v89, v121
    v_mul_f32 v90, v90, v121
    v_mul_f32 v91, v91, v121
    v_mul_f32 v92, v92, v121
    v_mul_f32 v93, v93, v121
    v_mul_f32 v94, v94, v121
    v_mul_f32 v95, v95, v121
    v_mul_f32 v96, v96, v121
    v_mul_f32 v97, v97, v121
    v_mul_f32 v98, v98, v121
    v_mul_f32 v99, v99, v121
    v_mul_f32 v100, v100, v121
    v_mul_f32 v101, v101, v121
    v_mul_f32 v102, v102, v121
    v_mul_f32 v103, v103, v121
    v_sub_f32 v32, v32, v120
    v_sub_f32 v33, v33, v120
    v_sub_f32 v34, v34, v120
    v_sub_f32 v35, v35, v120
    v_sub_f32 v36, v36, v120
    v_sub_f32 v37, v37, v120
    v_sub_f32 v38, v38, v120
    v_sub_f32 v39, v39, v120
    v_sub_f32 v40, v40, v120
    v_sub_f32 v41, v41, v120
    v_sub_f32 v42, v42, v120
    v_sub_f32 v43, v43, v120
    v_sub_f32 v44, v44, v120
    v_sub_f32 v45, v45, v120
    v_sub_f32 v46, v46, v120
    v_sub_f32 v47, v47, v120
    v_sub_f32 v72, v72, v120
    v_sub_f32 v73, v73, v120
    v_sub_f32 v74, v74, v120
    v_sub_f32 v75, v75, v120
    v_sub_f32 v76, v76, v120
    v_sub_f32 v77, v77, v120
    v_sub_f32 v78, v78, v120
    v_sub_f32 v79, v79, v120
    v_sub_f32 v80, v80, v120
    v_sub_f32 v81, v81, v120
    v_sub_f32 v82, v82, v120
    v_sub_f32 v83, v83, v120
    v_sub_f32 v84, v84, v120
    v_sub_f32 v85, v85, v120
    v_sub_f32 v86, v86, v120
    v_sub_f32 v87, v87, v120
    s_branch L_back_3
    s_nop 0
L_rare_4:
    v_mov_b32 v121, v120
    s_nop 1
    v_permlane32_swap_b32 v121, v120
    v_max_f32 v120, v120, v121
    v_max_f32 v120, 0, v120
    v_sub_f32 v121, 0, v120
    v_exp_f32 v121, v121
    s_nop 0
    v_mul_f32 v88, v88, v121
    v_mul_f32 v89, v89, v121
    v_mul_f32 v90, v90, v121
    v_mul_f32 v91, v91, v121
    v_mul_f32 v92, v92, v121
    v_mul_f32 v93, v93, v121
    v_mul_f32 v94, v94, v121
    v_mul_f32 v95, v95, v121
    v_mul_f32 v96, v96, v121
    v_mul_f32 v97, v97, v121
    v_mul_f32 v98, v98, v121
    v_mul_f32 v99, v99, v121
    v_mul_f32 v100, v100, v121
    v_mul_f32 v101, v101, v121
    v_mul_f32 v102, v102, v121
    v_mul_f32 v103, v103, v121
    v_sub_f32 v48, v48, v120
    v_sub_f32 v49, v49, v120
    v_sub_f32 v50, v50, v120
    v_sub_f32 v51, v51, v120
    v_sub_f32 v52, v52, v120
    v_sub_f32 v53, v53, v120
    v_sub_f32 v54, v54, v120
    v_sub_f32 v55, v55, v120
    v_sub_f32 v56, v56, v120
    v_sub_f32 v57, v57, v120
    v_sub_f32 v58, v58, v120
    v_sub_f32 v59, v59, v120
    v_sub_f32 v60, v60, v120
    v_sub_f32 v61, v61, v120
    v_sub_f32 v62, v62, v120
    v_sub_f32 v63, v63, v120
    v_sub_f32 v72, v72, v120
    v_sub_f32 v73, v73, v120
    v_sub_f32 v74, v74, v120
    v_sub_f32 v75, v75, v120
    v_sub_f32 v76, v76, v120
    v_sub_f32 v77, v77, v120
    v_sub_f32 v78, v78, v120
    v_sub_f32 v79, v79, v120
    v_sub_f32 v80, v80, v120
    v_sub_f32 v81, v81, v120
    v_sub_f32 v82, v82, v120
    v_sub_f32 v83, v83, v120
    v_sub_f32 v84, v84, v120
    v_sub_f32 v85, v85, v120
    v_sub_f32 v86, v86, v120
    v_sub_f32 v87, v87, v120
    s_branch L_back_4
    s_nop 0
L_rare_5:
    v_mov_b32 v121, v120
    s_nop 1
    v_permlane32_swap_b32 v121, v120
    v_max_f32 v120, v120, v121
    v_max_f32 v120, 0, v120
    v_sub_f32 v121, 0, v120
    v_exp_f32 v121, v121
    s_nop 0
    v_mul_f32 v88, v88, v121
    v_mul_f32 v89, v89, v121
    v_mul_f32 v90, v90, v121
    v_mul_f32 v91, v91, v121
    v_mul_f32 v92, v92, v121
    v_mul_f32 v93, v93, v121
    v_mul_f32 v94, v94, v121
    v_mul_f32 v95, v95, v121
    v_mul_f32 v96, v96, v121
    v_mul_f32 v97, v97, v121
    v_mul_f32 v98, v98, v121
    v_mul_f32 v99, v99, v121
    v_mul_f32 v100, v100, v121
    v_mul_f32 v101, v101, v121
    v_mul_f32 v102, v102, v121
    v_mul_f32 v103, v103, v121
    v_sub_f32 v32, v32, v120
    v_sub_f32 v33, v33, v120
    v_sub_f32 v34, v34, v120
    v_sub_f32 v35, v35, v120
    v_sub_f32 v36, v36, v120
    v_sub_f32 v37, v37, v120
    v_sub_f32 v38, v38, v120
    v_sub_f32 v39, v39, v120
    v_sub_f32 v40, v40, v120
    v_sub_f32 v41, v41, v120
    v_sub_f32 v42, v42, v120
    v_sub_f32 v43, v43, v120
    v_sub_f32 v44, v44, v120
    v_sub_f32 v45, v45, v120
    v_sub_f32 v46, v46, v120
    v_sub_f32 v47, v47, v120
    v_sub_f32 v72, v72, v120
    v_sub_f32 v73, v73, v120
    v_sub_f32 v74, v74, v120
    v_sub_f32 v75, v75, v120
    v_sub_f32 v76, v76, v120
    v_sub_f32 v77, v77, v120
    v_sub_f32 v78, v78, v120
    v_sub_f32 v79, v79, v120
    v_sub_f32 v80, v80, v120
    v_sub_f32 v81, v81, v120
    v_sub_f32 v82, v82, v120
    v_sub_f32 v83, v83, v120
    v_sub_f32 v84, v84, v120
    v_sub_f32 v85, v85, v120
    v_sub_f32 v86, v86, v120
    v_sub_f32 v87, v87, v120
    s_branch L_back_5
    s_nop 0
L_rare_6:
    v_mov_b32 v121, v120
    s_nop 1
    v_permlane32_swap_b32 v121, v120
    v_max_f32 v120, v120, v121
    v_max_f32 v120, 0, v120
    v_sub_f32 v121, 0, v120
    v_exp_f32 v121, v121
    s_nop 0
    v_mul_f32 v88, v88, v121
    v_mul_f32 v89, v89, v121
    v_mul_f32 v90, v90, v121
    v_mul_f32 v91, v91, v121
    v_mul_f32 v92, v92, v121
    v_mul_f32 v93, v93, v121
    v_mul_f32 v94, v94, v121
    v_mul_f32 v95, v95, v121
    v_mul_f32 v96, v96, v121
    v_mul_f32 v97, v97, v121
    v_mul_f32 v98, v98, v121
    v_mul_f32 v99, v99, v121
    v_mul_f32 v100, v100, v121
    v_mul_f32 v101, v101, v121
    v_mul_f32 v102, v102, v121
    v_mul_f32 v103, v103, v121
    v_sub_f32 v48, v48, v120
    v_sub_f32 v49, v49, v120
    v_sub_f32 v50, v50, v120
    v_sub_f32 v51, v51, v120
    v_sub_f32 v52, v52, v120
    v_sub_f32 v53, v53, v120
    v_sub_f32 v54, v54, v120
    v_sub_f32 v55, v55, v120
    v_sub_f32 v56, v56, v120
    v_sub_f32 v57, v57, v120
    v_sub_f32 v58, v58, v120
    v_sub_f32 v59, v59, v120
    v_sub_f32 v60, v60, v120
    v_sub_f32 v61, v61, v120
    v_sub_f32 v62, v62, v120
    v_sub_f32 v63, v63, v120
    v_sub_f32 v72, v72, v120
    v_sub_f32 v73, v73, v120
    v_sub_f32 v74, v74, v120
    v_sub_f32 v75, v75, v120
    v_sub_f32 v76, v76, v120
    v_sub_f32 v77, v77, v120
    v_sub_f32 v78, v78, v120
    v_sub_f32 v79, v79, v120
    v_sub_f32 v80, v80, v120
    v_sub_f32 v81, v81, v120
    v_sub_f32 v82, v82, v120
    v_sub_f32 v83, v83, v120
    v_sub_f32 v84, v84, v120
    v_sub_f32 v85, v85, v120
    v_sub_f32 v86, v86, v120
    v_sub_f32 v87, v87, v120
    s_branch L_back_6
    s_nop 0
L_rare_7:
    v_mov_b32 v121, v120
    s_nop 1
    v_permlane32_swap_b32 v121, v120
    v_max_f32 v120, v120, v121
    v_max_f32 v120, 0, v120
    v_sub_f32 v121, 0, v120
    v_exp_f32 v121, v121
    s_nop 0
    v_mul_f32 v88, v88, v121
    v_mul_f32 v89, v89, v121
    v_mul_f32 v90, v90, v121
    v_mul_f32 v91, v91, v121
    v_mul_f32 v92, v92, v121
    v_mul_f32 v93, v93, v121
    v_mul_f32 v94, v94, v121
    v_mul_f32 v95, v95, v121
    v_mul_f32 v96, v96, v121
    v_mul_f32 v97, v97, v121
    v_mul_f32 v98, v98, v121
    v_mul_f32 v99, v99, v121
    v_mul_f32 v100, v100, v121
    v_mul_f32 v101, v101, v121
    v_mul_f32 v102, v102, v121
    v_mul_f32 v103, v103, v121
    v_sub_f32 v32, v32, v120
    v_sub_f32 v33, v33, v120
    v_sub_f32 v34, v34, v120
    v_sub_f32 v35, v35, v120
    v_sub_f32 v36, v36, v120
    v_sub_f32 v37, v37, v120
    v_sub_f32 v38, v38, v120
    v_sub_f32 v39, v39, v120
    v_sub_f32 v40, v40, v120
    v_sub_f32 v41, v41, v120
    v_sub_f32 v42, v42, v120
    v_sub_f32 v43, v43, v120
    v_sub_f32 v44, v44, v120
    v_sub_f32 v45, v45, v120
    v_sub_f32 v46, v46, v120
    v_sub_f32 v47, v47, v120
    v_sub_f32 v72, v72, v120
    v_sub_f32 v73, v73, v120
    v_sub_f32 v74, v74, v120
    v_sub_f32 v75, v75, v120
    v_sub_f32 v76, v76, v120
    v_sub_f32 v77, v77, v120
    v_sub_f32 v78, v78, v120
    v_sub_f32 v79, v79, v120
    v_sub_f32 v80, v80, v120
    v_sub_f32 v81, v81, v120
    v_sub_f32 v82, v82, v120
    v_sub_f32 v83, v83, v120
    v_sub_f32 v84, v84, v120
    v_sub_f32 v85, v85, v120
    v_sub_f32 v86, v86, v120
    v_sub_f32 v87, v87, v120
    s_branch L_back_7
    s_nop 0
L_rare_8:
    v_mov_b32 v121, v120
    s_nop 1
    v_permlane32_swap_b32 v121, v120
    v_max_f32 v120, v120, v121
    v_max_f32 v120, 0, v120
    v_sub_f32 v121, 0, v120
    v_exp_f32 v121, v121
    s_nop 0
    v_mul_f32 v88, v88, v121
    v_mul_f32 v89, v89, v121
    v_mul_f32 v90, v90, v121
    v_mul_f32 v91, v91, v121
    v_mul_f32 v92, v92, v121
    v_mul_f32 v93, v93, v121
    v_mul_f32 v94, v94, v121
    v_mul_f32 v95, v95, v121
    v_mul_f32 v96, v96, v121
    v_mul_f32 v97, v97, v121
    v_mul_f32 v98, v98, v121
    v_mul_f32 v99, v99, v121
    v_mul_f32 v100, v100, v121
    v_mul_f32 v101, v101, v121
    v_mul_f32 v102, v102, v121
    v_mul_f32 v103, v103, v121
    v_sub_f32 v48, v48, v120
    v_sub_f32 v49, v49, v120
    v_sub_f32 v50, v50, v120
    v_sub_f32 v51, v51, v120
    v_sub_f32 v52, v52, v120
    v_sub_f32 v53, v53, v120
    v_sub_f32 v54, v54, v120
    v_sub_f32 v55, v55, v120
    v_sub_f32 v56, v56, v120
    v_sub_f32 v57, v57, v120
    v_sub_f32 v58, v58, v120
    v_sub_f32 v59, v59, v120
    v_sub_f32 v60, v60, v120
    v_sub_f32 v61, v61, v120
    v_sub_f32 v62, v62, v120
    v_sub_f32 v63, v63, v120
    v_sub_f32 v72, v72, v120
    v_sub_f32 v73, v73, v120
    v_sub_f32 v74, v74, v120
    v_sub_f32 v75, v75, v120
    v_sub_f32 v76, v76, v120
    v_sub_f32 v77, v77, v120
    v_sub_f32 v78, v78, v120
    v_sub_f32 v79, v79, v120
    v_sub_f32 v80, v80, v120
    v_sub_f32 v81, v81, v120
    v_sub_f32 v82, v82, v120
    v_sub_f32 v83, v83, v120
    v_sub_f32 v84, v84, v120
    v_sub_f32 v85, v85, v120
    v_sub_f32 v86, v86, v120
    v_sub_f32 v87, v87, v120
    s_branch L_back_8
    s_nop 0
L_rare_9:
    v_mov_b32 v121, v120
    s_nop 1
    v_permlane32_swap_b32 v121, v120
    v_max_f32 v120, v120, v121
    v_max_f32 v120, 0, v120
    v_sub_f32 v121, 0, v120
    v_exp_f32 v121, v121
    s_nop 0
    v_mul_f32 v88, v88, v121
    v_mul_f32 v89, v89, v121
    v_mul_f32 v90, v90, v121
    v_mul_f32 v91, v91, v121
    v_mul_f32 v92, v92, v121
    v_mul_f32 v93, v93, v121
    v_mul_f32 v94, v94, v121
    v_mul_f32 v95, v95, v121
    v_mul_f32 v96, v96, v121
    v_mul_f32 v97, v97, v121
    v_mul_f32 v98, v98, v121
    v_mul_f32 v99, v99, v121
    v_mul_f32 v100, v100, v121
    v_mul_f32 v101, v101, v121
    v_mul_f32 v102, v102, v121
    v_mul_f32 v103, v103, v121
    v_sub_f32 v32, v32, v120
    v_sub_f32 v33, v33, v120
    v_sub_f32 v34, v34, v120
    v_sub_f32 v35, v35, v120
    v_sub_f32 v36, v36, v120
    v_sub_f32 v37, v37, v120
    v_sub_f32 v38, v38, v120
    v_sub_f32 v39, v39, v120
    v_sub_f32 v40, v40, v120
    v_sub_f32 v41, v41, v120
    v_sub_f32 v42, v42, v120
    v_sub_f32 v43, v43, v120
    v_sub_f32 v44, v44, v120
    v_sub_f32 v45, v45, v120
    v_sub_f32 v46, v46, v120
    v_sub_f32 v47, v47, v120
    v_sub_f32 v72, v72, v120
    v_sub_f32 v73, v73, v120
    v_sub_f32 v74, v74, v120
    v_sub_f32 v75, v75, v120
    v_sub_f32 v76, v76, v120
    v_sub_f32 v77, v77, v120
    v_sub_f32 v78, v78, v120
    v_sub_f32 v79, v79, v120
    v_sub_f32 v80, v80, v120
    v_sub_f32 v81, v81, v120
    v_sub_f32 v82, v82, v120
    v_sub_f32 v83, v83, v120
    v_sub_f32 v84, v84, v120
    v_sub_f32 v85, v85, v120
    v_sub_f32 v86, v86, v120
    v_sub_f32 v87, v87, v120
    s_branch L_back_9
    s_nop 0
L_rare_10:
    v_mov_b32 v121, v120
    s_nop 1
    v_permlane32_swap_b32 v121, v120
    v_max_f32 v120, v120, v121
    v_max_f32 v120, 0, v120
    v_sub_f32 v121, 0, v120
    v_exp_f32 v121, v121
    s_nop 0
    v_mul_f32 v88, v88, v121
    v_mul_f32 v89, v89, v121
    v_mul_f32 v90, v90, v121
    v_mul_f32 v91, v91, v121
    v_mul_f32 v92, v92, v121
    v_mul_f32 v93, v93, v121
    v_mul_f32 v94, v94, v121
    v_mul_f32 v95, v95, v121
    v_mul_f32 v96, v96, v121
    v_mul_f32 v97, v97, v121
    v_mul_f32 v98, v98, v121
    v_mul_f32 v99, v99, v121
    v_mul_f32 v100, v100, v121
    v_mul_f32 v101, v101, v121
    v_mul_f32 v102, v102, v121
    v_mul_f32 v103, v103, v121
    v_sub_f32 v48, v48, v120
    v_sub_f32 v49, v49, v120
    v_sub_f32 v50, v50, v120
    v_sub_f32 v51, v51, v120
    v_sub_f32 v52, v52, v120
    v_sub_f32 v53, v53, v120
    v_sub_f32 v54, v54, v120
    v_sub_f32 v55, v55, v120
    v_sub_f32 v56, v56, v120
    v_sub_f32 v57, v57, v120
    v_sub_f32 v58, v58, v120
    v_sub_f32 v59, v59, v120
    v_sub_f32 v60, v60, v120
    v_sub_f32 v61, v61, v120
    v_sub_f32 v62, v62, v120
    v_sub_f32 v63, v63, v120
    v_sub_f32 v72, v72, v120
    v_sub_f32 v73, v73, v120
    v_sub_f32 v74, v74, v120
    v_sub_f32 v75, v75, v120
    v_sub_f32 v76, v76, v120
    v_sub_f32 v77, v77, v120
    v_sub_f32 v78, v78, v120
    v_sub_f32 v79, v79, v120
    v_sub_f32 v80, v80, v120
    v_sub_f32 v81, v81, v120
    v_sub_f32 v82, v82, v120
    v_sub_f32 v83, v83, v120
    v_sub_f32 v84, v84, v120
    v_sub_f32 v85, v85, v120
    v_sub_f32 v86, v86, v120
    v_sub_f32 v87, v87, v120
    s_branch L_back_10
    s_nop 0
L_rare_11:
    v_mov_b32 v121, v120
    s_nop 1
    v_permlane32_swap_b32 v121, v120
    v_max_f32 v120, v120, v121
    v_max_f32 v120, 0, v120
    v_sub_f32 v121, 0, v120
    v_exp_f32 v121, v121
    s_nop 0
    v_mul_f32 v88, v88, v121
    v_mul_f32 v89, v89, v121
    v_mul_f32 v90, v90, v121
    v_mul_f32 v91, v91, v121
    v_mul_f32 v92, v92, v121
    v_mul_f32 v93, v93, v121
    v_mul_f32 v94, v94, v121
    v_mul_f32 v95, v95, v121
    v_mul_f32 v96, v96, v121
    v_mul_f32 v97, v97, v121
    v_mul_f32 v98, v98, v121
    v_mul_f32 v99, v99, v121
    v_mul_f32 v100, v100, v121
    v_mul_f32 v101, v101, v121
    v_mul_f32 v102, v102, v121
    v_mul_f32 v103, v103, v121
    v_sub_f32 v32, v32, v120
    v_sub_f32 v33, v33, v120
    v_sub_f32 v34, v34, v120
    v_sub_f32 v35, v35, v120
    v_sub_f32 v36, v36, v120
    v_sub_f32 v37, v37, v120
    v_sub_f32 v38, v38, v120
    v_sub_f32 v39, v39, v120
    v_sub_f32 v40, v40, v120
    v_sub_f32 v41, v41, v120
    v_sub_f32 v42, v42, v120
    v_sub_f32 v43, v43, v120
    v_sub_f32 v44, v44, v120
    v_sub_f32 v45, v45, v120
    v_sub_f32 v46, v46, v120
    v_sub_f32 v47, v47, v120
    v_sub_f32 v72, v72, v120
    v_sub_f32 v73, v73, v120
    v_sub_f32 v74, v74, v120
    v_sub_f32 v75, v75, v120
    v_sub_f32 v76, v76, v120
    v_sub_f32 v77, v77, v120
    v_sub_f32 v78, v78, v120
    v_sub_f32 v79, v79, v120
    v_sub_f32 v80, v80, v120
    v_sub_f32 v81, v81, v120
    v_sub_f32 v82, v82, v120
    v_sub_f32 v83, v83, v120
    v_sub_f32 v84, v84, v120
    v_sub_f32 v85, v85, v120
    v_sub_f32 v86, v86, v120
    v_sub_f32 v87, v87, v120
    s_branch L_back_11
    s_nop 0
L_rare_12:
    v_mov_b32 v121, v120
    s_nop 1
    v_permlane32_swap_b32 v121, v120
    v_max_f32 v120, v120, v121
    v_max_f32 v120, 0, v120
    v_sub_f32 v121, 0, v120
    v_exp_f32 v121, v121
    s_nop 0
    v_mul_f32 v88, v88, v121
    v_mul_f32 v89, v89, v121
    v_mul_f32 v90, v90, v121
    v_mul_f32 v91, v91, v121
    v_mul_f32 v92, v92, v121
    v_mul_f32 v93, v93, v121
    v_mul_f32 v94, v94, v121
    v_mul_f32 v95, v95, v121
    v_mul_f32 v96, v96, v121
    v_mul_f32 v97, v97, v121
    v_mul_f32 v98, v98, v121
    v_mul_f32 v99, v99, v121
    v_mul_f32 v100, v100, v121
    v_mul_f32 v101, v101, v121
    v_mul_f32 v102, v102, v121
    v_mul_f32 v103, v103, v121
    v_sub_f32 v48, v48, v120
    v_sub_f32 v49, v49, v120
    v_sub_f32 v50, v50, v120
    v_sub_f32 v51, v51, v120
    v_sub_f32 v52, v52, v120
    v_sub_f32 v53, v53, v120
    v_sub_f32 v54, v54, v120
    v_sub_f32 v55, v55, v120
    v_sub_f32 v56, v56, v120
    v_sub_f32 v57, v57, v120
    v_sub_f32 v58, v58, v120
    v_sub_f32 v59, v59, v120
    v_sub_f32 v60, v60, v120
    v_sub_f32 v61, v61, v120
    v_sub_f32 v62, v62, v120
    v_sub_f32 v63, v63, v120
    v_sub_f32 v72, v72, v120
    v_sub_f32 v73, v73, v120
    v_sub_f32 v74, v74, v120
    v_sub_f32 v75, v75, v120
    v_sub_f32 v76, v76, v120
    v_sub_f32 v77, v77, v120
    v_sub_f32 v78, v78, v120
    v_sub_f32 v79, v79, v120
    v_sub_f32 v80, v80, v120
    v_sub_f32 v81, v81, v120
    v_sub_f32 v82, v82, v120
    v_sub_f32 v83, v83, v120
    v_sub_f32 v84, v84, v120
    v_sub_f32 v85, v85, v120
    v_sub_f32 v86, v86, v120
    v_sub_f32 v87, v87, v120
    s_branch L_back_12
    s_nop 0
L_rare_13:
    v_mov_b32 v121, v120
    s_nop 1
    v_permlane32_swap_b32 v121, v120
    v_max_f32 v120, v120, v121
    v_max_f32 v120, 0, v120
    v_sub_f32 v121, 0, v120
    v_exp_f32 v121, v121
    s_nop 0
    v_mul_f32 v88, v88, v121
    v_mul_f32 v89, v89, v121
    v_mul_f32 v90, v90, v121
    v_mul_f32 v91, v91, v121
    v_mul_f32 v92, v92, v121
    v_mul_f32 v93, v93, v121
    v_mul_f32 v94, v94, v121
    v_mul_f32 v95, v95, v121
    v_mul_f32 v96, v96, v121
    v_mul_f32 v97, v97, v121
    v_mul_f32 v98, v98, v121
    v_mul_f32 v99, v99, v121
    v_mul_f32 v100, v100, v121
    v_mul_f32 v101, v101, v121
    v_mul_f32 v102, v102, v121
    v_mul_f32 v103, v103, v121
    v_sub_f32 v32, v32, v120
    v_sub_f32 v33, v33, v120
    v_sub_f32 v34, v34, v120
    v_sub_f32 v35, v35, v120
    v_sub_f32 v36, v36, v120
    v_sub_f32 v37, v37, v120
    v_sub_f32 v38, v38, v120
    v_sub_f32 v39, v39, v120
    v_sub_f32 v40, v40, v120
    v_sub_f32 v41, v41, v120
    v_sub_f32 v42, v42, v120
    v_sub_f32 v43, v43, v120
    v_sub_f32 v44, v44, v120
    v_sub_f32 v45, v45, v120
    v_sub_f32 v46, v46, v120
    v_sub_f32 v47, v47, v120
    v_sub_f32 v72, v72, v120
    v_sub_f32 v73, v73, v120
    v_sub_f32 v74, v74, v120
    v_sub_f32 v75, v75, v120
    v_sub_f32 v76, v76, v120
    v_sub_f32 v77, v77, v120
    v_sub_f32 v78, v78, v120
    v_sub_f32 v79, v79, v120
    v_sub_f32 v80, v80, v120
    v_sub_f32 v81, v81, v120
    v_sub_f32 v82, v82, v120
    v_sub_f32 v83, v83, v120
    v_sub_f32 v84, v84, v120
    v_sub_f32 v85, v85, v120
    v_sub_f32 v86, v86, v120
    v_sub_f32 v87, v87, v120
    s_branch L_back_13
    s_nop 0
L_rare_14:
    v_mov_b32 v121, v120
    s_nop 1
    v_permlane32_swap_b32 v121, v120
    v_max_f32 v120, v120, v121
    v_max_f32 v120, 0, v120
    v_sub_f32 v121, 0, v120
    v_exp_f32 v121, v121
    s_nop 0
    v_mul_f32 v88, v88, v121
    v_mul_f32 v89, v89, v121
    v_mul_f32 v90, v90, v121
    v_mul_f32 v91, v91, v121
    v_mul_f32 v92, v92, v121
    v_mul_f32 v93, v93, v121
    v_mul_f32 v94, v94, v121
    v_mul_f32 v95, v95, v121
    v_mul_f32 v96, v96, v121
    v_mul_f32 v97, v97, v121
    v_mul_f32 v98, v98, v121
    v_mul_f32 v99, v99, v121
    v_mul_f32 v100, v100, v121
    v_mul_f32 v101, v101, v121
    v_mul_f32 v102, v102, v121
    v_mul_f32 v103, v103, v121
    v_sub_f32 v48, v48, v120
    v_sub_f32 v49, v49, v120
    v_sub_f32 v50, v50, v120
    v_sub_f32 v51, v51, v120
    v_sub_f32 v52, v52, v120
    v_sub_f32 v53, v53, v120
    v_sub_f32 v54, v54, v120
    v_sub_f32 v55, v55, v120
    v_sub_f32 v56, v56, v120
    v_sub_f32 v57, v57, v120
    v_sub_f32 v58, v58, v120
    v_sub_f32 v59, v59, v120
    v_sub_f32 v60, v60, v120
    v_sub_f32 v61, v61, v120
    v_sub_f32 v62, v62, v120
    v_sub_f32 v63, v63, v120
    v_sub_f32 v72, v72, v120
    v_sub_f32 v73, v73, v120
    v_sub_f32 v74, v74, v120
    v_sub_f32 v75, v75, v120
    v_sub_f32 v76, v76, v120
    v_sub_f32 v77, v77, v120
    v_sub_f32 v78, v78, v120
    v_sub_f32 v79, v79, v120
    v_sub_f32 v80, v80, v120
    v_sub_f32 v81, v81, v120
    v_sub_f32 v82, v82, v120
    v_sub_f32 v83, v83, v120
    v_sub_f32 v84, v84, v120
    v_sub_f32 v85, v85, v120
    v_sub_f32 v86, v86, v120
    v_sub_f32 v87, v87, v120
    s_branch L_back_14
    s_nop 0
L_rare_15:
    v_mov_b32 v121, v120
    s_nop 1
    v_permlane32_swap_b32 v121, v120
    v_max_f32 v120, v120, v121
    v_max_f32 v120, 0, v120
    v_sub_f32 v121, 0, v120
    v_exp_f32 v121, v121
    s_nop 0
    v_mul_f32 v88, v88, v121
    v_mul_f32 v89, v89, v121
    v_mul_f32 v90, v90, v121
    v_mul_f32 v91, v91, v121
    v_mul_f32 v92, v92, v121
    v_mul_f32 v93, v93, v121
    v_mul_f32 v94, v94, v121
    v_mul_f32 v95, v95, v121
    v_mul_f32 v96, v96, v121
    v_mul_f32 v97, v97, v121
    v_mul_f32 v98, v98, v121
    v_mul_f32 v99, v99, v121
    v_mul_f32 v100, v100, v121
    v_mul_f32 v101, v101, v121
    v_mul_f32 v102, v102, v121
    v_mul_f32 v103, v103, v121
    v_sub_f32 v32, v32, v120
    v_sub_f32 v33, v33, v120
    v_sub_f32 v34, v34, v120
    v_sub_f32 v35, v35, v120
    v_sub_f32 v36, v36, v120
    v_sub_f32 v37, v37, v120
    v_sub_f32 v38, v38, v120
    v_sub_f32 v39, v39, v120
    v_sub_f32 v40, v40, v120
    v_sub_f32 v41, v41, v120
    v_sub_f32 v42, v42, v120
    v_sub_f32 v43, v43, v120
    v_sub_f32 v44, v44, v120
    v_sub_f32 v45, v45, v120
    v_sub_f32 v46, v46, v120
    v_sub_f32 v47, v47, v120
    v_sub_f32 v72, v72, v120
    v_sub_f32 v73, v73, v120
    v_sub_f32 v74, v74, v120
    v_sub_f32 v75, v75, v120
    v_sub_f32 v76, v76, v120
    v_sub_f32 v77, v77, v120
    v_sub_f32 v78, v78, v120
    v_sub_f32 v79, v79, v120
    v_sub_f32 v80, v80, v120
    v_sub_f32 v81, v81, v120
    v_sub_f32 v82, v82, v120
    v_sub_f32 v83, v83, v120
    v_sub_f32 v84, v84, v120
    v_sub_f32 v85, v85, v120
    v_sub_f32 v86, v86, v120
    v_sub_f32 v87, v87, v120
    s_branch L_back_15
    s_nop 0
L_rare_16:
    v_mov_b32 v121, v120
    s_nop 1
    v_permlane32_swap_b32 v121, v120
    v_max_f32 v120, v120, v121
    v_max_f32 v120, 0, v120
    v_sub_f32 v121, 0, v120
    v_exp_f32 v121, v121
    s_nop 0
    v_mul_f32 v88, v88, v121
    v_mul_f32 v89, v89, v121
    v_mul_f32 v90, v90, v121
    v_mul_f32 v91, v91, v121
    v_mul_f32 v92, v92, v121
    v_mul_f32 v93, v93, v121
    v_mul_f32 v94, v94, v121
    v_mul_f32 v95, v95, v121
    v_mul_f32 v96, v96, v121
    v_mul_f32 v97, v97, v121
    v_mul_f32 v98, v98, v121
    v_mul_f32 v99, v99, v121
    v_mul_f32 v100, v100, v121
    v_mul_f32 v101, v101, v121
    v_mul_f32 v102, v102, v121
    v_mul_f32 v103, v103, v121
    v_sub_f32 v32, v32, v120
    v_sub_f32 v33, v33, v120
    v_sub_f32 v34, v34, v120
    v_sub_f32 v35, v35, v120
    v_sub_f32 v36, v36, v120
    v_sub_f32 v37, v37, v120
    v_sub_f32 v38, v38, v120
    v_sub_f32 v39, v39, v120
    v_sub_f32 v40, v40, v120
    v_sub_f32 v41, v41, v120
    v_sub_f32 v42, v42, v120
    v_sub_f32 v43, v43, v120
    v_sub_f32 v44, v44, v120
    v_sub_f32 v45, v45, v120
    v_sub_f32 v46, v46, v120
    v_sub_f32 v47, v47, v120
    v_sub_f32 v72, v72, v120
    v_sub_f32 v73, v73, v120
    v_sub_f32 v74, v74, v120
    v_sub_f32 v75, v75, v120
    v_sub_f32 v76, v76, v120
    v_sub_f32 v77, v77, v120
    v_sub_f32 v78, v78, v120
    v_sub_f32 v79, v79, v120
    v_sub_f32 v80, v80, v120
    v_sub_f32 v81, v81, v120
    v_sub_f32 v82, v82, v120
    v_sub_f32 v83, v83, v120
    v_sub_f32 v84, v84, v120
    v_sub_f32 v85, v85, v120
    v_sub_f32 v86, v86, v120
    v_sub_f32 v87, v87, v120
    s_branch L_back_16
    s_nop 0
L_rare_17:
    v_mov_b32 v121, v120
    s_nop 1
    v_permlane32_swap_b32 v121, v120
    v_max_f32 v120, v120, v121
    v_max_f32 v120, 0, v120
    v_sub_f32 v121, 0, v120
    v_exp_f32 v121, v121
    s_nop 0
    v_mul_f32 v88, v88, v121
    v_mul_f32 v89, v89, v121
    v_mul_f32 v90, v90, v121
    v_mul_f32 v91, v91, v121
    v_mul_f32 v92, v92, v121
    v_mul_f32 v93, v93, v121
    v_mul_f32 v94, v94, v121
    v_mul_f32 v95, v95, v121
    v_mul_f32 v96, v96, v121
    v_mul_f32 v97, v97, v121
    v_mul_f32 v98, v98, v121
    v_mul_f32 v99, v99, v121
    v_mul_f32 v100, v100, v121
    v_mul_f32 v101, v101, v121
    v_mul_f32 v102, v102, v121
    v_mul_f32 v103, v103, v121
    v_sub_f32 v32, v32, v120
    v_sub_f32 v33, v33, v120
    v_sub_f32 v34, v34, v120
    v_sub_f32 v35, v35, v120
    v_sub_f32 v36, v36, v120
    v_sub_f32 v37, v37, v120
    v_sub_f32 v38, v38, v120
    v_sub_f32 v39, v39, v120
    v_sub_f32 v40, v40, v120
    v_sub_f32 v41, v41, v120
    v_sub_f32 v42, v42, v120
    v_sub_f32 v43, v43, v120
    v_sub_f32 v44, v44, v120
    v_sub_f32 v45, v45, v120
    v_sub_f32 v46, v46, v120
    v_sub_f32 v47, v47, v120
    v_sub_f32 v72, v72, v120
    v_sub_f32 v73, v73, v120
    v_sub_f32 v74, v74, v120
    v_sub_f32 v75, v75, v120
    v_sub_f32 v76, v76, v120
    v_sub_f32 v77, v77, v120
    v_sub_f32 v78, v78, v120
    v_sub_f32 v79, v79, v120
    v_sub_f32 v80, v80, v120
    v_sub_f32 v81, v81, v120
    v_sub_f32 v82, v82, v120
    v_sub_f32 v83, v83, v120
    v_sub_f32 v84, v84, v120
    v_sub_f32 v85, v85, v120
    v_sub_f32 v86, v86, v120
    v_sub_f32 v87, v87, v120
    s_branch L_back_17
    s_nop 0
L_rare_18:
    v_mov_b32 v121, v120
    s_nop 1
    v_permlane32_swap_b32 v121, v120
    v_max_f32 v120, v120, v121
    v_max_f32 v120, 0, v120
    v_sub_f32 v121, 0, v120
    v_exp_f32 v121, v121
    s_nop 0
    v_mul_f32 v88, v88, v121
    v_mul_f32 v89, v89, v121
    v_mul_f32 v90, v90, v121
    v_mul_f32 v91, v91, v121
    v_mul_f32 v92, v92, v121
    v_mul_f32 v93, v93, v121
    v_mul_f32 v94, v94, v121
    v_mul_f32 v95, v95, v121
    v_mul_f32 v96, v96, v121
    v_mul_f32 v97, v97, v121
    v_mul_f32 v98, v98, v121
    v_mul_f32 v99, v99, v121
    v_mul_f32 v100, v100, v121
    v_mul_f32 v101, v101, v121
    v_mul_f32 v102, v102, v121
    v_mul_f32 v103, v103, v121
    v_sub_f32 v32, v32, v120
    v_sub_f32 v33, v33, v120
    v_sub_f32 v34, v34, v120
    v_sub_f32 v35, v35, v120
    v_sub_f32 v36, v36, v120
    v_sub_f32 v37, v37, v120
    v_sub_f32 v38, v38, v120
    v_sub_f32 v39, v39, v120
    v_sub_f32 v40, v40, v120
    v_sub_f32 v41, v41, v120
    v_sub_f32 v42, v42, v120
    v_sub_f32 v43, v43, v120
    v_sub_f32 v44, v44, v120
    v_sub_f32 v45, v45, v120
    v_sub_f32 v46, v46, v120
    v_sub_f32 v47, v47, v120
    v_sub_f32 v72, v72, v120
    v_sub_f32 v73, v73, v120
    v_sub_f32 v74, v74, v120
    v_sub_f32 v75, v75, v120
    v_sub_f32 v76, v76, v120
    v_sub_f32 v77, v77, v120
    v_sub_f32 v78, v78, v120
    v_sub_f32 v79, v79, v120
    v_sub_f32 v80, v80, v120
    v_sub_f32 v81, v81, v120
    v_sub_f32 v82, v82, v120
    v_sub_f32 v83, v83, v120
    v_sub_f32 v84, v84, v120
    v_sub_f32 v85, v85, v120
    v_sub_f32 v86, v86, v120
    v_sub_f32 v87, v87, v120
    s_branch L_back_18
    s_nop 0
L_rare_19:
    v_mov_b32 v121, v120
    s_nop 1
    v_permlane32_swap_b32 v121, v120
    v_max_f32 v120, v120, v121
    v_max_f32 v120, 0, v120
    v_sub_f32 v121, 0, v120
    v_exp_f32 v121, v121
    s_nop 0
    v_mul_f32 v88, v88, v121
    v_mul_f32 v89, v89, v121
    v_mul_f32 v90, v90, v121
    v_mul_f32 v91, v91, v121
    v_mul_f32 v92, v92, v121
    v_mul_f32 v93, v93, v121
    v_mul_f32 v94, v94, v121
    v_mul_f32 v95, v95, v121
    v_mul_f32 v96, v96, v121
    v_mul_f32 v97, v97, v121
    v_mul_f32 v98, v98, v121
    v_mul_f32 v99, v99, v121
    v_mul_f32 v100, v100, v121
    v_mul_f32 v101, v101, v121
    v_mul_f32 v102, v102, v121
    v_mul_f32 v103, v103, v121
    v_sub_f32 v32, v32, v120
    v_sub_f32 v33, v33, v120
    v_sub_f32 v34, v34, v120
    v_sub_f32 v35, v35, v120
    v_sub_f32 v36, v36, v120
    v_sub_f32 v37, v37, v120
    v_sub_f32 v38, v38, v120
    v_sub_f32 v39, v39, v120
    v_sub_f32 v40, v40, v120
    v_sub_f32 v41, v41, v120
    v_sub_f32 v42, v42, v120
    v_sub_f32 v43, v43, v120
    v_sub_f32 v44, v44, v120
    v_sub_f32 v45, v45, v120
    v_sub_f32 v46, v46, v120
    v_sub_f32 v47, v47, v120
    v_sub_f32 v72, v72, v120
    v_sub_f32 v73, v73, v120
    v_sub_f32 v74, v74, v120
    v_sub_f32 v75, v75, v120
    v_sub_f32 v76, v76, v120
    v_sub_f32 v77, v77, v120
    v_sub_f32 v78, v78, v120
    v_sub_f32 v79, v79, v120
    v_sub_f32 v80, v80, v120
    v_sub_f32 v81, v81, v120
    v_sub_f32 v82, v82, v120
    v_sub_f32 v83, v83, v120
    v_sub_f32 v84, v84, v120
    v_sub_f32 v85, v85, v120
    v_sub_f32 v86, v86, v120
    v_sub_f32 v87, v87, v120
    s_branch L_back_19
    s_nop 0
L_rare_20:
    v_mov_b32 v121, v120
    s_nop 1
    v_permlane32_swap_b32 v121, v120
    v_max_f32 v120, v120, v121
    v_max_f32 v120, 0, v120
    v_sub_f32 v121, 0, v120
    v_exp_f32 v121, v121
    s_nop 0
    v_mul_f32 v88, v88, v121
    v_mul_f32 v89, v89, v121
    v_mul_f32 v90, v90, v121
    v_mul_f32 v91, v91, v121
    v_mul_f32 v92, v92, v121
    v_mul_f32 v93, v93, v121
    v_mul_f32 v94, v94, v121
    v_mul_f32 v95, v95, v121
    v_mul_f32 v96, v96, v121
    v_mul_f32 v97, v97, v121
    v_mul_f32 v98, v98, v121
    v_mul_f32 v99, v99, v121
    v_mul_f32 v100, v100, v121
    v_mul_f32 v101, v101, v121
    v_mul_f32 v102, v102, v121
    v_mul_f32 v103, v103, v121
    v_sub_f32 v32, v32, v120
    v_sub_f32 v33, v33, v120
    v_sub_f32 v34, v34, v120
    v_sub_f32 v35, v35, v120
    v_sub_f32 v36, v36, v120
    v_sub_f32 v37, v37, v120
    v_sub_f32 v38, v38, v120
    v_sub_f32 v39, v39, v120
    v_sub_f32 v40, v40, v120
    v_sub_f32 v41, v41, v120
    v_sub_f32 v42, v42, v120
    v_sub_f32 v43, v43, v120
    v_sub_f32 v44, v44, v120
    v_sub_f32 v45, v45, v120
    v_sub_f32 v46, v46, v120
    v_sub_f32 v47, v47, v120
    v_sub_f32 v72, v72, v120
    v_sub_f32 v73, v73, v120
    v_sub_f32 v74, v74, v120
    v_sub_f32 v75, v75, v120
    v_sub_f32 v76, v76, v120
    v_sub_f32 v77, v77, v120
    v_sub_f32 v78, v78, v120
    v_sub_f32 v79, v79, v120
    v_sub_f32 v80, v80, v120
    v_sub_f32 v81, v81, v120
    v_sub_f32 v82, v82, v120
    v_sub_f32 v83, v83, v120
    v_sub_f32 v84, v84, v120
    v_sub_f32 v85, v85, v120
    v_sub_f32 v86, v86, v120
    v_sub_f32 v87, v87, v120
    s_branch L_back_20
    s_nop 0
L_rare_21:
    v_mov_b32 v121, v120
    s_nop 1
    v_permlane32_swap_b32 v121, v120
    v_max_f32 v120, v120, v121
    v_max_f32 v120, 0, v120
    v_sub_f32 v121, 0, v120
    v_exp_f32 v121, v121
    s_nop 0
    v_mul_f32 v88, v88, v121
    v_mul_f32 v89, v89, v121
    v_mul_f32 v90, v90, v121
    v_mul_f32 v91, v91, v121
    v_mul_f32 v92, v92, v121
    v_mul_f32 v93, v93, v121
    v_mul_f32 v94, v94, v121
    v_mul_f32 v95, v95, v121
    v_mul_f32 v96, v96, v121
    v_mul_f32 v97, v97, v121
    v_mul_f32 v98, v98, v121
    v_mul_f32 v99, v99, v121
    v_mul_f32 v100, v100, v121
    v_mul_f32 v101, v101, v121
    v_mul_f32 v102, v102, v121
    v_mul_f32 v103, v103, v121
    v_sub_f32 v32, v32, v120
    v_sub_f32 v33, v33, v120
    v_sub_f32 v34, v34, v120
    v_sub_f32 v35, v35, v120
    v_sub_f32 v36, v36, v120
    v_sub_f32 v37, v37, v120
    v_sub_f32 v38, v38, v120
    v_sub_f32 v39, v39, v120
    v_sub_f32 v40, v40, v120
    v_sub_f32 v41, v41, v120
    v_sub_f32 v42, v42, v120
    v_sub_f32 v43, v43, v120
    v_sub_f32 v44, v44, v120
    v_sub_f32 v45, v45, v120
    v_sub_f32 v46, v46, v120
    v_sub_f32 v47, v47, v120
    v_sub_f32 v72, v72, v120
    v_sub_f32 v73, v73, v120
    v_sub_f32 v74, v74, v120
    v_sub_f32 v75, v75, v120
    v_sub_f32 v76, v76, v120
    v_sub_f32 v77, v77, v120
    v_sub_f32 v78, v78, v120
    v_sub_f32 v79, v79, v120
    v_sub_f32 v80, v80, v120
    v_sub_f32 v81, v81, v120
    v_sub_f32 v82, v82, v120
    v_sub_f32 v83, v83, v120
    v_sub_f32 v84, v84, v120
    v_sub_f32 v85, v85, v120
    v_sub_f32 v86, v86, v120
    v_sub_f32 v87, v87, v120
    s_branch L_back_21
    s_nop 0
L_rare_22:
    v_mov_b32 v121, v120
    s_nop 1
    v_permlane32_swap_b32 v121, v120
    v_max_f32 v120, v120, v121
    v_max_f32 v120, 0, v120
    v_sub_f32 v121, 0, v120
    v_exp_f32 v121, v121
    s_nop 0
    v_mul_f32 v88, v88, v121
    v_mul_f32 v89, v89, v121
    v_mul_f32 v90, v90, v121
    v_mul_f32 v91, v91, v121
    v_mul_f32 v92, v92, v121
    v_mul_f32 v93, v93, v121
    v_mul_f32 v94, v94, v121
    v_mul_f32 v95, v95, v121
    v_mul_f32 v96, v96, v121
    v_mul_f32 v97, v97, v121
    v_mul_f32 v98, v98, v121
    v_mul_f32 v99, v99, v121
    v_mul_f32 v100, v100, v121
    v_mul_f32 v101, v101, v121
    v_mul_f32 v102, v102, v121
    v_mul_f32 v103, v103, v121
    v_sub_f32 v32, v32, v120
    v_sub_f32 v33, v33, v120
    v_sub_f32 v34, v34, v120
    v_sub_f32 v35, v35, v120
    v_sub_f32 v36, v36, v120
    v_sub_f32 v37, v37, v120
    v_sub_f32 v38, v38, v120
    v_sub_f32 v39, v39, v120
    v_sub_f32 v40, v40, v120
    v_sub_f32 v41, v41, v120
    v_sub_f32 v42, v42, v120
    v_sub_f32 v43, v43, v120
    v_sub_f32 v44, v44, v120
    v_sub_f32 v45, v45, v120
    v_sub_f32 v46, v46, v120
    v_sub_f32 v47, v47, v120
    v_sub_f32 v72, v72, v120
    v_sub_f32 v73, v73, v120
    v_sub_f32 v74, v74, v120
    v_sub_f32 v75, v75, v120
    v_sub_f32 v76, v76, v120
    v_sub_f32 v77, v77, v120
    v_sub_f32 v78, v78, v120
    v_sub_f32 v79, v79, v120
    v_sub_f32 v80, v80, v120
    v_sub_f32 v81, v81, v120
    v_sub_f32 v82, v82, v120
    v_sub_f32 v83, v83, v120
    v_sub_f32 v84, v84, v120
    v_sub_f32 v85, v85, v120
    v_sub_f32 v86, v86, v120
    v_sub_f32 v87, v87, v120
    s_branch L_back_22
    s_nop 0
L_rare_23:
    v_mov_b32 v121, v120
    s_nop 1
    v_permlane32_swap_b32 v121, v120
    v_max_f32 v120, v120, v121
    v_max_f32 v120, 0, v120
    v_sub_f32 v121, 0, v120
    v_exp_f32 v121, v121
    s_nop 0
    v_mul_f32 v88, v88, v121
    v_mul_f32 v89, v89, v121
    v_mul_f32 v90, v90, v121
    v_mul_f32 v91, v91, v121
    v_mul_f32 v92, v92, v121
    v_mul_f32 v93, v93, v121
    v_mul_f32 v94, v94, v121
    v_mul_f32 v95, v95, v121
    v_mul_f32 v96, v96, v121
    v_mul_f32 v97, v97, v121
    v_mul_f32 v98, v98, v121
    v_mul_f32 v99, v99, v121
    v_mul_f32 v100, v100, v121
    v_mul_f32 v101, v101, v121
    v_mul_f32 v102, v102, v121
    v_mul_f32 v103, v103, v121
    v_sub_f32 v32, v32, v120
    v_sub_f32 v33, v33, v120
    v_sub_f32 v34, v34, v120
    v_sub_f32 v35, v35, v120
    v_sub_f32 v36, v36, v120
    v_sub_f32 v37, v37, v120
    v_sub_f32 v38, v38, v120
    v_sub_f32 v39, v39, v120
    v_sub_f32 v40, v40, v120
    v_sub_f32 v41, v41, v120
    v_sub_f32 v42, v42, v120
    v_sub_f32 v43, v43, v120
    v_sub_f32 v44, v44, v120
    v_sub_f32 v45, v45, v120
    v_sub_f32 v46, v46, v120
    v_sub_f32 v47, v47, v120
    v_sub_f32 v72, v72, v120
    v_sub_f32 v73, v73, v120
    v_sub_f32 v74, v74, v120
    v_sub_f32 v75, v75, v120
    v_sub_f32 v76, v76, v120
    v_sub_f32 v77, v77, v120
    v_sub_f32 v78, v78, v120
    v_sub_f32 v79, v79, v120
    v_sub_f32 v80, v80, v120
    v_sub_f32 v81, v81, v120
    v_sub_f32 v82, v82, v120
    v_sub_f32 v83, v83, v120
    v_sub_f32 v84, v84, v120
    v_sub_f32 v85, v85, v120
    v_sub_f32 v86, v86, v120
    v_sub_f32 v87, v87, v120
    s_branch L_back_23
    s_nop 0
L_rare_24:
    v_mov_b32 v121, v120
    s_nop 1
    v_permlane32_swap_b32 v121, v120
    v_max_f32 v120, v120, v121
    v_max_f32 v120, 0, v120
    v_sub_f32 v121, 0, v120
    v_exp_f32 v121, v121
    s_nop 0
    v_mul_f32 v88, v88, v121
    v_mul_f32 v89, v89, v121
    v_mul_f32 v90, v90, v121
    v_mul_f32 v91, v91, v121
    v_mul_f32 v92, v92, v121
    v_mul_f32 v93, v93, v121
    v_mul_f32 v94, v94, v121
    v_mul_f32 v95, v95, v121
    v_mul_f32 v96, v96, v121
    v_mul_f32 v97, v97, v121
    v_mul_f32 v98, v98, v121
    v_mul_f32 v99, v99, v121
    v_mul_f32 v100, v100, v121
    v_mul_f32 v101, v101, v121
    v_mul_f32 v102, v102, v121
    v_mul_f32 v103, v103, v121
    v_sub_f32 v32, v32, v120
    v_sub_f32 v33, v33, v120
    v_sub_f32 v34, v34, v120
    v_sub_f32 v35, v35, v120
    v_sub_f32 v36, v36, v120
    v_sub_f32 v37, v37, v120
    v_sub_f32 v38, v38, v120
    v_sub_f32 v39, v39, v120
    v_sub_f32 v40, v40, v120
    v_sub_f32 v41, v41, v120
    v_sub_f32 v42, v42, v120
    v_sub_f32 v43, v43, v120
    v_sub_f32 v44, v44, v120
    v_sub_f32 v45, v45, v120
    v_sub_f32 v46, v46, v120
    v_sub_f32 v47, v47, v120
    v_sub_f32 v72, v72, v120
    v_sub_f32 v73, v73, v120
    v_sub_f32 v74, v74, v120
    v_sub_f32 v75, v75, v120
    v_sub_f32 v76, v76, v120
    v_sub_f32 v77, v77, v120
    v_sub_f32 v78, v78, v120
    v_sub_f32 v79, v79, v120
    v_sub_f32 v80, v80, v120
    v_sub_f32 v81, v81, v120
    v_sub_f32 v82, v82, v120
    v_sub_f32 v83, v83, v120
    v_sub_f32 v84, v84, v120
    v_sub_f32 v85, v85, v120
    v_sub_f32 v86, v86, v120
    v_sub_f32 v87, v87, v120
    s_branch L_back_24
    s_nop 0
L_rare_25:
    v_mov_b32 v121, v120
    s_nop 1
    v_permlane32_swap_b32 v121, v120
    v_max_f32 v120, v120, v121
    v_max_f32 v120, 0, v120
    v_sub_f32 v121, 0, v120
    v_exp_f32 v121, v121
    s_nop 0
    v_mul_f32 v88, v88, v121
    v_mul_f32 v89, v89, v121
    v_mul_f32 v90, v90, v121
    v_mul_f32 v91, v91, v121
    v_mul_f32 v92, v92, v121
    v_mul_f32 v93, v93, v121
    v_mul_f32 v94, v94, v121
    v_mul_f32 v95, v95, v121
    v_mul_f32 v96, v96, v121
    v_mul_f32 v97, v97, v121
    v_mul_f32 v98, v98, v121
    v_mul_f32 v99, v99, v121
    v_mul_f32 v100, v100, v121
    v_mul_f32 v101, v101, v121
    v_mul_f32 v102, v102, v121
    v_mul_f32 v103, v103, v121
    v_sub_f32 v32, v32, v120
    v_sub_f32 v33, v33, v120
    v_sub_f32 v34, v34, v120
    v_sub_f32 v35, v35, v120
    v_sub_f32 v36, v36, v120
    v_sub_f32 v37, v37, v120
    v_sub_f32 v38, v38, v120
    v_sub_f32 v39, v39, v120
    v_sub_f32 v40, v40, v120
    v_sub_f32 v41, v41, v120
    v_sub_f32 v42, v42, v120
    v_sub_f32 v43, v43, v120
    v_sub_f32 v44, v44, v120
    v_sub_f32 v45, v45, v120
    v_sub_f32 v46, v46, v120
    v_sub_f32 v47, v47, v120
    v_sub_f32 v72, v72, v120
    v_sub_f32 v73, v73, v120
    v_sub_f32 v74, v74, v120
    v_sub_f32 v75, v75, v120
    v_sub_f32 v76, v76, v120
    v_sub_f32 v77, v77, v120
    v_sub_f32 v78, v78, v120
    v_sub_f32 v79, v79, v120
    v_sub_f32 v80, v80, v120
    v_sub_f32 v81, v81, v120
    v_sub_f32 v82, v82, v120
    v_sub_f32 v83, v83, v120
    v_sub_f32 v84, v84, v120
    v_sub_f32 v85, v85, v120
    v_sub_f32 v86, v86, v120
    v_sub_f32 v87, v87, v120
    s_branch L_back_25
    s_nop 0
L_rare_26:
    v_mov_b32 v121, v120
    s_nop 1
    v_permlane32_swap_b32 v121, v120
    v_max_f32 v120, v120, v121
    v_max_f32 v120, 0, v120
    v_sub_f32 v121, 0, v120
    v_exp_f32 v121, v121
    s_nop 0
    v_mul_f32 v88, v88, v121
    v_mul_f32 v89, v89, v121
    v_mul_f32 v90, v90, v121
    v_mul_f32 v91, v91, v121
    v_mul_f32 v92, v92, v121
    v_mul_f32 v93, v93, v121
    v_mul_f32 v94, v94, v121
    v_mul_f32 v95, v95, v121
    v_mul_f32 v96, v96, v121
    v_mul_f32 v97, v97, v121
    v_mul_f32 v98, v98, v121
    v_mul_f32 v99, v99, v121
    v_mul_f32 v100, v100, v121
    v_mul_f32 v101, v101, v121
    v_mul_f32 v102, v102, v121
    v_mul_f32 v103, v103, v121
    v_sub_f32 v32, v32, v120
    v_sub_f32 v33, v33, v120
    v_sub_f32 v34, v34, v120
    v_sub_f32 v35, v35, v120
    v_sub_f32 v36, v36, v120
    v_sub_f32 v37, v37, v120
    v_sub_f32 v38, v38, v120
    v_sub_f32 v39, v39, v120
    v_sub_f32 v40, v40, v120
    v_sub_f32 v41, v41, v120
    v_sub_f32 v42, v42, v120
    v_sub_f32 v43, v43, v120
    v_sub_f32 v44, v44, v120
    v_sub_f32 v45, v45, v120
    v_sub_f32 v46, v46, v120
    v_sub_f32 v47, v47, v120
    v_sub_f32 v72, v72, v120
    v_sub_f32 v73, v73, v120
    v_sub_f32 v74, v74, v120
    v_sub_f32 v75, v75, v120
    v_sub_f32 v76, v76, v120
    v_sub_f32 v77, v77, v120
    v_sub_f32 v78, v78, v120
    v_sub_f32 v79, v79, v120
    v_sub_f32 v80, v80, v120
    v_sub_f32 v81, v81, v120
    v_sub_f32 v82, v82, v120
    v_sub_f32 v83, v83, v120
    v_sub_f32 v84, v84, v120
    v_sub_f32 v85, v85, v120
    v_sub_f32 v86, v86, v120
    v_sub_f32 v87, v87, v120
    s_branch L_back_26
    s_nop 0
L_rare_27:
    v_mov_b32 v121, v120
    s_nop 1
    v_permlane32_swap_b32 v121, v120
    v_max_f32 v120, v120, v121
    v_max_f32 v120, 0, v120
    v_sub_f32 v121, 0, v120
    v_exp_f32 v121, v121
    s_nop 0
    v_mul_f32 v88, v88, v121
    v_mul_f32 v89, v89, v121
    v_mul_f32 v90, v90, v121
    v_mul_f32 v91, v91, v121
    v_mul_f32 v92, v92, v121
    v_mul_f32 v93, v93, v121
    v_mul_f32 v94, v94, v121
    v_mul_f32 v95, v95, v121
    v_mul_f32 v96, v96, v121
    v_mul_f32 v97, v97, v121
    v_mul_f32 v98, v98, v121
    v_mul_f32 v99, v99, v121
    v_mul_f32 v100, v100, v121
    v_mul_f32 v101, v101, v121
    v_mul_f32 v102, v102, v121
    v_mul_f32 v103, v103, v121
    v_sub_f32 v32, v32, v120
    v_sub_f32 v33, v33, v120
    v_sub_f32 v34, v34, v120
    v_sub_f32 v35, v35, v120
    v_sub_f32 v36, v36, v120
    v_sub_f32 v37, v37, v120
    v_sub_f32 v38, v38, v120
    v_sub_f32 v39, v39, v120
    v_sub_f32 v40, v40, v120
    v_sub_f32 v41, v41, v120
    v_sub_f32 v42, v42, v120
    v_sub_f32 v43, v43, v120
    v_sub_f32 v44, v44, v120
    v_sub_f32 v45, v45, v120
    v_sub_f32 v46, v46, v120
    v_sub_f32 v47, v47, v120
    v_sub_f32 v72, v72, v120
    v_sub_f32 v73, v73, v120
    v_sub_f32 v74, v74, v120
    v_sub_f32 v75, v75, v120
    v_sub_f32 v76, v76, v120
    v_sub_f32 v77, v77, v120
    v_sub_f32 v78, v78, v120
    v_sub_f32 v79, v79, v120
    v_sub_f32 v80, v80, v120
    v_sub_f32 v81, v81, v120
    v_sub_f32 v82, v82, v120
    v_sub_f32 v83, v83, v120
    v_sub_f32 v84, v84, v120
    v_sub_f32 v85, v85, v120
    v_sub_f32 v86, v86, v120
    v_sub_f32 v87, v87, v120
    s_branch L_back_27
    s_nop 0
L_rare_28:
    v_mov_b32 v121, v120
    s_nop 1
    v_permlane32_swap_b32 v121, v120
    v_max_f32 v120, v120, v121
    v_max_f32 v120, 0, v120
    v_sub_f32 v121, 0, v120
    v_exp_f32 v121, v121
    s_nop 0
    v_mul_f32 v88, v88, v121
    v_mul_f32 v89, v89, v121
    v_mul_f32 v90, v90, v121
    v_mul_f32 v91, v91, v121
    v_mul_f32 v92, v92, v121
    v_mul_f32 v93, v93, v121
    v_mul_f32 v94, v94, v121
    v_mul_f32 v95, v95, v121
    v_mul_f32 v96, v96, v121
    v_mul_f32 v97, v97, v121
    v_mul_f32 v98, v98, v121
    v_mul_f32 v99, v99, v121
    v_mul_f32 v100, v100, v121
    v_mul_f32 v101, v101, v121
    v_mul_f32 v102, v102, v121
    v_mul_f32 v103, v103, v121
    v_sub_f32 v32, v32, v120
    v_sub_f32 v33, v33, v120
    v_sub_f32 v34, v34, v120
    v_sub_f32 v35, v35, v120
    v_sub_f32 v36, v36, v120
    v_sub_f32 v37, v37, v120
    v_sub_f32 v38, v38, v120
    v_sub_f32 v39, v39, v120
    v_sub_f32 v40, v40, v120
    v_sub_f32 v41, v41, v120
    v_sub_f32 v42, v42, v120
    v_sub_f32 v43, v43, v120
    v_sub_f32 v44, v44, v120
    v_sub_f32 v45, v45, v120
    v_sub_f32 v46, v46, v120
    v_sub_f32 v47, v47, v120
    v_sub_f32 v72, v72, v120
    v_sub_f32 v73, v73, v120
    v_sub_f32 v74, v74, v120
    v_sub_f32 v75, v75, v120
    v_sub_f32 v76, v76, v120
    v_sub_f32 v77, v77, v120
    v_sub_f32 v78, v78, v120
    v_sub_f32 v79, v79, v120
    v_sub_f32 v80, v80, v120
    v_sub_f32 v81, v81, v120
    v_sub_f32 v82, v82, v120
    v_sub_f32 v83, v83, v120
    v_sub_f32 v84, v84, v120
    v_sub_f32 v85, v85, v120
    v_sub_f32 v86, v86, v120
    v_sub_f32 v87, v87, v120
    s_branch L_back_28
    s_nop 0
L_rare_29:
    v_mov_b32 v121, v120
    s_nop 1
    v_permlane32_swap_b32 v121, v120
    v_max_f32 v120, v120, v121
    v_max_f32 v120, 0, v120
    v_sub_f32 v121, 0, v120
    v_exp_f32 v121, v121
    s_nop 0
    v_mul_f32 v88, v88, v121
    v_mul_f32 v89, v89, v121
    v_mul_f32 v90, v90, v121
    v_mul_f32 v91, v91, v121
    v_mul_f32 v92, v92, v121
    v_mul_f32 v93, v93, v121
    v_mul_f32 v94, v94, v121
    v_mul_f32 v95, v95, v121
    v_mul_f32 v96, v96, v121
    v_mul_f32 v97, v97, v121
    v_mul_f32 v98, v98, v121
    v_mul_f32 v99, v99, v121
    v_mul_f32 v100, v100, v121
    v_mul_f32 v101, v101, v121
    v_mul_f32 v102, v102, v121
    v_mul_f32 v103, v103, v121
    v_sub_f32 v32, v32, v120
    v_sub_f32 v33, v33, v120
    v_sub_f32 v34, v34, v120
    v_sub_f32 v35, v35, v120
    v_sub_f32 v36, v36, v120
    v_sub_f32 v37, v37, v120
    v_sub_f32 v38, v38, v120
    v_sub_f32 v39, v39, v120
    v_sub_f32 v40, v40, v120
    v_sub_f32 v41, v41, v120
    v_sub_f32 v42, v42, v120
    v_sub_f32 v43, v43, v120
    v_sub_f32 v44, v44, v120
    v_sub_f32 v45, v45, v120
    v_sub_f32 v46, v46, v120
    v_sub_f32 v47, v47, v120
    v_sub_f32 v72, v72, v120
    v_sub_f32 v73, v73, v120
    v_sub_f32 v74, v74, v120
    v_sub_f32 v75, v75, v120
    v_sub_f32 v76, v76, v120
    v_sub_f32 v77, v77, v120
    v_sub_f32 v78, v78, v120
    v_sub_f32 v79, v79, v120
    v_sub_f32 v80, v80, v120
    v_sub_f32 v81, v81, v120
    v_sub_f32 v82, v82, v120
    v_sub_f32 v83, v83, v120
    v_sub_f32 v84, v84, v120
    v_sub_f32 v85, v85, v120
    v_sub_f32 v86, v86, v120
    v_sub_f32 v87, v87, v120
    s_branch L_back_29
    s_nop 0
L_rare_30:
    v_mov_b32 v121, v120
    s_nop 1
    v_permlane32_swap_b32 v121, v120
    v_max_f32 v120, v120, v121
    v_max_f32 v120, 0, v120
    v_sub_f32 v121, 0, v120
    v_exp_f32 v121, v121
    s_nop 0
    v_mul_f32 v88, v88, v121
    v_mul_f32 v89, v89, v121
    v_mul_f32 v90, v90, v121
    v_mul_f32 v91, v91, v121
    v_mul_f32 v92, v92, v121
    v_mul_f32 v93, v93, v121
    v_mul_f32 v94, v94, v121
    v_mul_f32 v95, v95, v121
    v_mul_f32 v96, v96, v121
    v_mul_f32 v97, v97, v121
    v_mul_f32 v98, v98, v121
    v_mul_f32 v99, v99, v121
    v_mul_f32 v100, v100, v121
    v_mul_f32 v101, v101, v121
    v_mul_f32 v102, v102, v121
    v_mul_f32 v103, v103, v121
    v_sub_f32 v32, v32, v120
    v_sub_f32 v33, v33, v120
    v_sub_f32 v34, v34, v120
    v_sub_f32 v35, v35, v120
    v_sub_f32 v36, v36, v120
    v_sub_f32 v37, v37, v120
    v_sub_f32 v38, v38, v120
    v_sub_f32 v39, v39, v120
    v_sub_f32 v40, v40, v120
    v_sub_f32 v41, v41, v120
    v_sub_f32 v42, v42, v120
    v_sub_f32 v43, v43, v120
    v_sub_f32 v44, v44, v120
    v_sub_f32 v45, v45, v120
    v_sub_f32 v46, v46, v120
    v_sub_f32 v47, v47, v120
    v_sub_f32 v72, v72, v120
    v_sub_f32 v73, v73, v120
    v_sub_f32 v74, v74, v120
    v_sub_f32 v75, v75, v120
    v_sub_f32 v76, v76, v120
    v_sub_f32 v77, v77, v120
    v_sub_f32 v78, v78, v120
    v_sub_f32 v79, v79, v120
    v_sub_f32 v80, v80, v120
    v_sub_f32 v81, v81, v120
    v_sub_f32 v82, v82, v120
    v_sub_f32 v83, v83, v120
    v_sub_f32 v84, v84, v120
    v_sub_f32 v85, v85, v120
    v_sub_f32 v86, v86, v120
    v_sub_f32 v87, v87, v120
    s_branch L_back_30
    s_nop 0
L_rare_31:
    v_mov_b32 v121, v120
    s_nop 1
    v_permlane32_swap_b32 v121, v120
    v_max_f32 v120, v120, v121
    v_max_f32 v120, 0, v120
    v_sub_f32 v121, 0, v120
    v_exp_f32 v121, v121
    s_nop 0
    v_mul_f32 v88, v88, v121
    v_mul_f32 v89, v89, v121
    v_mul_f32 v90, v90, v121
    v_mul_f32 v91, v91, v121
    v_mul_f32 v92, v92, v121
    v_mul_f32 v93, v93, v121
    v_mul_f32 v94, v94, v121
    v_mul_f32 v95, v95, v121
    v_mul_f32 v96, v96, v121
    v_mul_f32 v97, v97, v121
    v_mul_f32 v98, v98, v121
    v_mul_f32 v99, v99, v121
    v_mul_f32 v100, v100, v121
    v_mul_f32 v101, v101, v121
    v_mul_f32 v102, v102, v121
    v_mul_f32 v103, v103, v121
    v_sub_f32 v32, v32, v120
    v_sub_f32 v33, v33, v120
    v_sub_f32 v34, v34, v120
    v_sub_f32 v35, v35, v120
    v_sub_f32 v36, v36, v120
    v_sub_f32 v37, v37, v120
    v_sub_f32 v38, v38, v120
    v_sub_f32 v39, v39, v120
    v_sub_f32 v40, v40, v120
    v_sub_f32 v41, v41, v120
    v_sub_f32 v42, v42, v120
    v_sub_f32 v43, v43, v120
    v_sub_f32 v44, v44, v120
    v_sub_f32 v45, v45, v120
    v_sub_f32 v46, v46, v120
    v_sub_f32 v47, v47, v120
    v_sub_f32 v72, v72, v120
    v_sub_f32 v73, v73, v120
    v_sub_f32 v74, v74, v120
    v_sub_f32 v75, v75, v120
    v_sub_f32 v76, v76, v120
    v_sub_f32 v77, v77, v120
    v_sub_f32 v78, v78, v120
    v_sub_f32 v79, v79, v120
    v_sub_f32 v80, v80, v120
    v_sub_f32 v81, v81, v120
    v_sub_f32 v82, v82, v120
    v_sub_f32 v83, v83, v120
    v_sub_f32 v84, v84, v120
    v_sub_f32 v85, v85, v120
    v_sub_f32 v86, v86, v120
    v_sub_f32 v87, v87, v120
    s_branch L_back_31
    s_nop 0
L_rare_32:
    v_mov_b32 v121, v120
    s_nop 1
    v_permlane32_swap_b32 v121, v120
    v_max_f32 v120, v120, v121
    v_max_f32 v120, 0, v120
    v_sub_f32 v121, 0, v120
    v_exp_f32 v121, v121
    s_nop 0
    v_mul_f32 v88, v88, v121
    v_mul_f32 v89, v89, v121
    v_mul_f32 v90, v90, v121
    v_mul_f32 v91, v91, v121
    v_mul_f32 v92, v92, v121
    v_mul_f32 v93, v93, v121
    v_mul_f32 v94, v94, v121
    v_mul_f32 v95, v95, v121
    v_mul_f32 v96, v96, v121
    v_mul_f32 v97, v97, v121
    v_mul_f32 v98, v98, v121
    v_mul_f32 v99, v99, v121
    v_mul_f32 v100, v100, v121
    v_mul_f32 v101, v101, v121
    v_mul_f32 v102, v102, v121
    v_mul_f32 v103, v103, v121
    v_sub_f32 v32, v32, v120
    v_sub_f32 v33, v33, v120
    v_sub_f32 v34, v34, v120
    v_sub_f32 v35, v35, v120
    v_sub_f32 v36, v36, v120
    v_sub_f32 v37, v37, v120
    v_sub_f32 v38, v38, v120
    v_sub_f32 v39, v39, v120
    v_sub_f32 v40, v40, v120
    v_sub_f32 v41, v41, v120
    v_sub_f32 v42, v42, v120
    v_sub_f32 v43, v43, v120
    v_sub_f32 v44, v44, v120
    v_sub_f32 v45, v45, v120
    v_sub_f32 v46, v46, v120
    v_sub_f32 v47, v47, v120
    v_sub_f32 v72, v72, v120
    v_sub_f32 v73, v73, v120
    v_sub_f32 v74, v74, v120
    v_sub_f32 v75, v75, v120
    v_sub_f32 v76, v76, v120
    v_sub_f32 v77, v77, v120
    v_sub_f32 v78, v78, v120
    v_sub_f32 v79, v79, v120
    v_sub_f32 v80, v80, v120
    v_sub_f32 v81, v81, v120
    v_sub_f32 v82, v82, v120
    v_sub_f32 v83, v83, v120
    v_sub_f32 v84, v84, v120
    v_sub_f32 v85, v85, v120
    v_sub_f32 v86, v86, v120
    v_sub_f32 v87, v87, v120
    s_branch L_back_32
    s_nop 0
L_rare_33:
    v_mov_b32 v121, v120
    s_nop 1
    v_permlane32_swap_b32 v121, v120
    v_max_f32 v120, v120, v121
    v_max_f32 v120, 0, v120
    v_sub_f32 v121, 0, v120
    v_exp_f32 v121, v121
    s_nop 0
    v_mul_f32 v88, v88, v121
    v_mul_f32 v89, v89, v121
    v_mul_f32 v90, v90, v121
    v_mul_f32 v91, v91, v121
    v_mul_f32 v92, v92, v121
    v_mul_f32 v93, v93, v121
    v_mul_f32 v94, v94, v121
    v_mul_f32 v95, v95, v121
    v_mul_f32 v96, v96, v121
    v_mul_f32 v97, v97, v121
    v_mul_f32 v98, v98, v121
    v_mul_f32 v99, v99, v121
    v_mul_f32 v100, v100, v121
    v_mul_f32 v101, v101, v121
    v_mul_f32 v102, v102, v121
    v_mul_f32 v103, v103, v121
    v_sub_f32 v32, v32, v120
    v_sub_f32 v33, v33, v120
    v_sub_f32 v34, v34, v120
    v_sub_f32 v35, v35, v120
    v_sub_f32 v36, v36, v120
    v_sub_f32 v37, v37, v120
    v_sub_f32 v38, v38, v120
    v_sub_f32 v39, v39, v120
    v_sub_f32 v40, v40, v120
    v_sub_f32 v41, v41, v120
    v_sub_f32 v42, v42, v120
    v_sub_f32 v43, v43, v120
    v_sub_f32 v44, v44, v120
    v_sub_f32 v45, v45, v120
    v_sub_f32 v46, v46, v120
    v_sub_f32 v47, v47, v120
    v_sub_f32 v72, v72, v120
    v_sub_f32 v73, v73, v120
    v_sub_f32 v74, v74, v120
    v_sub_f32 v75, v75, v120
    v_sub_f32 v76, v76, v120
    v_sub_f32 v77, v77, v120
    v_sub_f32 v78, v78, v120
    v_sub_f32 v79, v79, v120
    v_sub_f32 v80, v80, v120
    v_sub_f32 v81, v81, v120
    v_sub_f32 v82, v82, v120
    v_sub_f32 v83, v83, v120
    v_sub_f32 v84, v84, v120
    v_sub_f32 v85, v85, v120
    v_sub_f32 v86, v86, v120
    v_sub_f32 v87, v87, v120
    s_branch L_back_33
    s_nop 0
L_rare_34:
    v_mov_b32 v121, v120
    s_nop 1
    v_permlane32_swap_b32 v121, v120
    v_max_f32 v120, v120, v121
    v_max_f32 v120, 0, v120
    v_sub_f32 v121, 0, v120
    v_exp_f32 v121, v121
    s_nop 0
    v_mul_f32 v88, v88, v121
    v_mul_f32 v89, v89, v121
    v_mul_f32 v90, v90, v121
    v_mul_f32 v91, v91, v121
    v_mul_f32 v92, v92, v121
    v_mul_f32 v93, v93, v121
    v_mul_f32 v94, v94, v121
    v_mul_f32 v95, v95, v121
    v_mul_f32 v96, v96, v121
    v_mul_f32 v97, v97, v121
    v_mul_f32 v98, v98, v121
    v_mul_f32 v99, v99, v121
    v_mul_f32 v100, v100, v121
    v_mul_f32 v101, v101, v121
    v_mul_f32 v102, v102, v121
    v_mul_f32 v103, v103, v121
    v_sub_f32 v32, v32, v120
    v_sub_f32 v33, v33, v120
    v_sub_f32 v34, v34, v120
    v_sub_f32 v35, v35, v120
    v_sub_f32 v36, v36, v120
    v_sub_f32 v37, v37, v120
    v_sub_f32 v38, v38, v120
    v_sub_f32 v39, v39, v120
    v_sub_f32 v40, v40, v120
    v_sub_f32 v41, v41, v120
    v_sub_f32 v42, v42, v120
    v_sub_f32 v43, v43, v120
    v_sub_f32 v44, v44, v120
    v_sub_f32 v45, v45, v120
    v_sub_f32 v46, v46, v120
    v_sub_f32 v47, v47, v120
    v_sub_f32 v72, v72, v120
    v_sub_f32 v73, v73, v120
    v_sub_f32 v74, v74, v120
    v_sub_f32 v75, v75, v120
    v_sub_f32 v76, v76, v120
    v_sub_f32 v77, v77, v120
    v_sub_f32 v78, v78, v120
    v_sub_f32 v79, v79, v120
    v_sub_f32 v80, v80, v120
    v_sub_f32 v81, v81, v120
    v_sub_f32 v82, v82, v120
    v_sub_f32 v83, v83, v120
    v_sub_f32 v84, v84, v120
    v_sub_f32 v85, v85, v120
    v_sub_f32 v86, v86, v120
    v_sub_f32 v87, v87, v120
    s_branch L_back_34
    s_nop 0
L_rare_35:
    v_mov_b32 v121, v120
    s_nop 1
    v_permlane32_swap_b32 v121, v120
    v_max_f32 v120, v120, v121
    v_max_f32 v120, 0, v120
    v_sub_f32 v121, 0, v120
    v_exp_f32 v121, v121
    s_nop 0
    v_mul_f32 v88, v88, v121
    v_mul_f32 v89, v89, v121
    v_mul_f32 v90, v90, v121
    v_mul_f32 v91, v91, v121
    v_mul_f32 v92, v92, v121
    v_mul_f32 v93, v93, v121
    v_mul_f32 v94, v94, v121
    v_mul_f32 v95, v95, v121
    v_mul_f32 v96, v96, v121
    v_mul_f32 v97, v97, v121
    v_mul_f32 v98, v98, v121
    v_mul_f32 v99, v99, v121
    v_mul_f32 v100, v100, v121
    v_mul_f32 v101, v101, v121
    v_mul_f32 v102, v102, v121
    v_mul_f32 v103, v103, v121
    v_sub_f32 v32, v32, v120
    v_sub_f32 v33, v33, v120
    v_sub_f32 v34, v34, v120
    v_sub_f32 v35, v35, v120
    v_sub_f32 v36, v36, v120
    v_sub_f32 v37, v37, v120
    v_sub_f32 v38, v38, v120
    v_sub_f32 v39, v39, v120
    v_sub_f32 v40, v40, v120
    v_sub_f32 v41, v41, v120
    v_sub_f32 v42, v42, v120
    v_sub_f32 v43, v43, v120
    v_sub_f32 v44, v44, v120
    v_sub_f32 v45, v45, v120
    v_sub_f32 v46, v46, v120
    v_sub_f32 v47, v47, v120
    v_sub_f32 v72, v72, v120
    v_sub_f32 v73, v73, v120
    v_sub_f32 v74, v74, v120
    v_sub_f32 v75, v75, v120
    v_sub_f32 v76, v76, v120
    v_sub_f32 v77, v77, v120
    v_sub_f32 v78, v78, v120
    v_sub_f32 v79, v79, v120
    v_sub_f32 v80, v80, v120
    v_sub_f32 v81, v81, v120
    v_sub_f32 v82, v82, v120
    v_sub_f32 v83, v83, v120
    v_sub_f32 v84, v84, v120
    v_sub_f32 v85, v85, v120
    v_sub_f32 v86, v86, v120
    v_sub_f32 v87, v87, v120
    s_branch L_back_35
    s_nop 0
L_rare_36:
    v_mov_b32 v121, v120
    s_nop 1
    v_permlane32_swap_b32 v121, v120
    v_max_f32 v120, v120, v121
    v_max_f32 v120, 0, v120
    v_sub_f32 v121, 0, v120
    v_exp_f32 v121, v121
    s_nop 0
    v_mul_f32 v88, v88, v121
    v_mul_f32 v89, v89, v121
    v_mul_f32 v90, v90, v121
    v_mul_f32 v91, v91, v121
    v_mul_f32 v92, v92, v121
    v_mul_f32 v93, v93, v121
    v_mul_f32 v94, v94, v121
    v_mul_f32 v95, v95, v121
    v_mul_f32 v96, v96, v121
    v_mul_f32 v97, v97, v121
    v_mul_f32 v98, v98, v121
    v_mul_f32 v99, v99, v121
    v_mul_f32 v100, v100, v121
    v_mul_f32 v101, v101, v121
    v_mul_f32 v102, v102, v121
    v_mul_f32 v103, v103, v121
    v_sub_f32 v32, v32, v120
    v_sub_f32 v33, v33, v120
    v_sub_f32 v34, v34, v120
    v_sub_f32 v35, v35, v120
    v_sub_f32 v36, v36, v120
    v_sub_f32 v37, v37, v120
    v_sub_f32 v38, v38, v120
    v_sub_f32 v39, v39, v120
    v_sub_f32 v40, v40, v120
    v_sub_f32 v41, v41, v120
    v_sub_f32 v42, v42, v120
    v_sub_f32 v43, v43, v120
    v_sub_f32 v44, v44, v120
    v_sub_f32 v45, v45, v120
    v_sub_f32 v46, v46, v120
    v_sub_f32 v47, v47, v120
    v_sub_f32 v72, v72, v120
    v_sub_f32 v73, v73, v120
    v_sub_f32 v74, v74, v120
    v_sub_f32 v75, v75, v120
    v_sub_f32 v76, v76, v120
    v_sub_f32 v77, v77, v120
    v_sub_f32 v78, v78, v120
    v_sub_f32 v79, v79, v120
    v_sub_f32 v80, v80, v120
    v_sub_f32 v81, v81, v120
    v_sub_f32 v82, v82, v120
    v_sub_f32 v83, v83, v120
    v_sub_f32 v84, v84, v120
    v_sub_f32 v85, v85, v120
    v_sub_f32 v86, v86, v120
    v_sub_f32 v87, v87, v120
    s_branch L_back_36
    s_nop 0
L_rare_37:
    v_mov_b32 v121, v120
    s_nop 1
    v_permlane32_swap_b32 v121, v120
    v_max_f32 v120, v120, v121
    v_max_f32 v120, 0, v120
    v_sub_f32 v121, 0, v120
    v_exp_f32 v121, v121
    s_nop 0
    v_mul_f32 v88, v88, v121
    v_mul_f32 v89, v89, v121
    v_mul_f32 v90, v90, v121
    v_mul_f32 v91, v91, v121
    v_mul_f32 v92, v92, v121
    v_mul_f32 v93, v93, v121
    v_mul_f32 v94, v94, v121
    v_mul_f32 v95, v95, v121
    v_mul_f32 v96, v96, v121
    v_mul_f32 v97, v97, v121
    v_mul_f32 v98, v98, v121
    v_mul_f32 v99, v99, v121
    v_mul_f32 v100, v100, v121
    v_mul_f32 v101, v101, v121
    v_mul_f32 v102, v102, v121
    v_mul_f32 v103, v103, v121
    v_sub_f32 v32, v32, v120
    v_sub_f32 v33, v33, v120
    v_sub_f32 v34, v34, v120
    v_sub_f32 v35, v35, v120
    v_sub_f32 v36, v36, v120
    v_sub_f32 v37, v37, v120
    v_sub_f32 v38, v38, v120
    v_sub_f32 v39, v39, v120
    v_sub_f32 v40, v40, v120
    v_sub_f32 v41, v41, v120
    v_sub_f32 v42, v42, v120
    v_sub_f32 v43, v43, v120
    v_sub_f32 v44, v44, v120
    v_sub_f32 v45, v45, v120
    v_sub_f32 v46, v46, v120
    v_sub_f32 v47, v47, v120
    v_sub_f32 v72, v72, v120
    v_sub_f32 v73, v73, v120
    v_sub_f32 v74, v74, v120
    v_sub_f32 v75, v75, v120
    v_sub_f32 v76, v76, v120
    v_sub_f32 v77, v77, v120
    v_sub_f32 v78, v78, v120
    v_sub_f32 v79, v79, v120
    v_sub_f32 v80, v80, v120
    v_sub_f32 v81, v81, v120
    v_sub_f32 v82, v82, v120
    v_sub_f32 v83, v83, v120
    v_sub_f32 v84, v84, v120
    v_sub_f32 v85, v85, v120
    v_sub_f32 v86, v86, v120
    v_sub_f32 v87, v87, v120
    s_branch L_back_37
    s_nop 0
L_rare_38:
    v_mov_b32 v121, v120
    s_nop 1
    v_permlane32_swap_b32 v121, v120
    v_max_f32 v120, v120, v121
    v_max_f32 v120, 0, v120
    v_sub_f32 v121, 0, v120
    v_exp_f32 v121, v121
    s_nop 0
    v_mul_f32 v88, v88, v121
    v_mul_f32 v89, v89, v121
    v_mul_f32 v90, v90, v121
    v_mul_f32 v91, v91, v121
    v_mul_f32 v92, v92, v121
    v_mul_f32 v93, v93, v121
    v_mul_f32 v94, v94, v121
    v_mul_f32 v95, v95, v121
    v_mul_f32 v96, v96, v121
    v_mul_f32 v97, v97, v121
    v_mul_f32 v98, v98, v121
    v_mul_f32 v99, v99, v121
    v_mul_f32 v100, v100, v121
    v_mul_f32 v101, v101, v121
    v_mul_f32 v102, v102, v121
    v_mul_f32 v103, v103, v121
    v_sub_f32 v32, v32, v120
    v_sub_f32 v33, v33, v120
    v_sub_f32 v34, v34, v120
    v_sub_f32 v35, v35, v120
    v_sub_f32 v36, v36, v120
    v_sub_f32 v37, v37, v120
    v_sub_f32 v38, v38, v120
    v_sub_f32 v39, v39, v120
    v_sub_f32 v40, v40, v120
    v_sub_f32 v41, v41, v120
    v_sub_f32 v42, v42, v120
    v_sub_f32 v43, v43, v120
    v_sub_f32 v44, v44, v120
    v_sub_f32 v45, v45, v120
    v_sub_f32 v46, v46, v120
    v_sub_f32 v47, v47, v120
    v_sub_f32 v72, v72, v120
    v_sub_f32 v73, v73, v120
    v_sub_f32 v74, v74, v120
    v_sub_f32 v75, v75, v120
    v_sub_f32 v76, v76, v120
    v_sub_f32 v77, v77, v120
    v_sub_f32 v78, v78, v120
    v_sub_f32 v79, v79, v120
    v_sub_f32 v80, v80, v120
    v_sub_f32 v81, v81, v120
    v_sub_f32 v82, v82, v120
    v_sub_f32 v83, v83, v120
    v_sub_f32 v84, v84, v120
    v_sub_f32 v85, v85, v120
    v_sub_f32 v86, v86, v120
    v_sub_f32 v87, v87, v120
    s_branch L_back_38
    s_nop 0
L_rare_39:
    v_mov_b32 v121, v120
    s_nop 1
    v_permlane32_swap_b32 v121, v120
    v_max_f32 v120, v120, v121
    v_max_f32 v120, 0, v120
    v_sub_f32 v121, 0, v120
    v_exp_f32 v121, v121
    s_nop 0
    v_mul_f32 v88, v88, v121
    v_mul_f32 v89, v89, v121
    v_mul_f32 v90, v90, v121
    v_mul_f32 v91, v91, v121
    v_mul_f32 v92, v92, v121
    v_mul_f32 v93, v93, v121
    v_mul_f32 v94, v94, v121
    v_mul_f32 v95, v95, v121
    v_mul_f32 v96, v96, v121
    v_mul_f32 v97, v97, v121
    v_mul_f32 v98, v98, v121
    v_mul_f32 v99, v99, v121
    v_mul_f32 v100, v100, v121
    v_mul_f32 v101, v101, v121
    v_mul_f32 v102, v102, v121
    v_mul_f32 v103, v103, v121
    v_sub_f32 v32, v32, v120
    v_sub_f32 v33, v33, v120
    v_sub_f32 v34, v34, v120
    v_sub_f32 v35, v35, v120
    v_sub_f32 v36, v36, v120
    v_sub_f32 v37, v37, v120
    v_sub_f32 v38, v38, v120
    v_sub_f32 v39, v39, v120
    v_sub_f32 v40, v40, v120
    v_sub_f32 v41, v41, v120
    v_sub_f32 v42, v42, v120
    v_sub_f32 v43, v43, v120
    v_sub_f32 v44, v44, v120
    v_sub_f32 v45, v45, v120
    v_sub_f32 v46, v46, v120
    v_sub_f32 v47, v47, v120
    v_sub_f32 v72, v72, v120
    v_sub_f32 v73, v73, v120
    v_sub_f32 v74, v74, v120
    v_sub_f32 v75, v75, v120
    v_sub_f32 v76, v76, v120
    v_sub_f32 v77, v77, v120
    v_sub_f32 v78, v78, v120
    v_sub_f32 v79, v79, v120
    v_sub_f32 v80, v80, v120
    v_sub_f32 v81, v81, v120
    v_sub_f32 v82, v82, v120
    v_sub_f32 v83, v83, v120
    v_sub_f32 v84, v84, v120
    v_sub_f32 v85, v85, v120
    v_sub_f32 v86, v86, v120
    v_sub_f32 v87, v87, v120
    s_branch L_back_39
    s_nop 0
L_rare_40:
    v_mov_b32 v121, v120
    s_nop 1
    v_permlane32_swap_b32 v121, v120
    v_max_f32 v120, v120, v121
    v_max_f32 v120, 0, v120
    v_sub_f32 v121, 0, v120
    v_exp_f32 v121, v121
    s_nop 0
    v_mul_f32 v88, v88, v121
    v_mul_f32 v89, v89, v121
    v_mul_f32 v90, v90, v121
    v_mul_f32 v91, v91, v121
    v_mul_f32 v92, v92, v121
    v_mul_f32 v93, v93, v121
    v_mul_f32 v94, v94, v121
    v_mul_f32 v95, v95, v121
    v_mul_f32 v96, v96, v121
    v_mul_f32 v97, v97, v121
    v_mul_f32 v98, v98, v121
    v_mul_f32 v99, v99, v121
    v_mul_f32 v100, v100, v121
    v_mul_f32 v101, v101, v121
    v_mul_f32 v102, v102, v121
    v_mul_f32 v103, v103, v121
    v_sub_f32 v32, v32, v120
    v_sub_f32 v33, v33, v120
    v_sub_f32 v34, v34, v120
    v_sub_f32 v35, v35, v120
    v_sub_f32 v36, v36, v120
    v_sub_f32 v37, v37, v120
    v_sub_f32 v38, v38, v120
    v_sub_f32 v39, v39, v120
    v_sub_f32 v40, v40, v120
    v_sub_f32 v41, v41, v120
    v_sub_f32 v42, v42, v120
    v_sub_f32 v43, v43, v120
    v_sub_f32 v44, v44, v120
    v_sub_f32 v45, v45, v120
    v_sub_f32 v46, v46, v120
    v_sub_f32 v47, v47, v120
    v_sub_f32 v72, v72, v120
    v_sub_f32 v73, v73, v120
    v_sub_f32 v74, v74, v120
    v_sub_f32 v75, v75, v120
    v_sub_f32 v76, v76, v120
    v_sub_f32 v77, v77, v120
    v_sub_f32 v78, v78, v120
    v_sub_f32 v79, v79, v120
    v_sub_f32 v80, v80, v120
    v_sub_f32 v81, v81, v120
    v_sub_f32 v82, v82, v120
    v_sub_f32 v83, v83, v120
    v_sub_f32 v84, v84, v120
    v_sub_f32 v85, v85, v120
    v_sub_f32 v86, v86, v120
    v_sub_f32 v87, v87, v120
    s_branch L_back_40
    s_nop 0
L_rare_41:
    v_mov_b32 v121, v120
    s_nop 1
    v_permlane32_swap_b32 v121, v120
    v_max_f32 v120, v120, v121
    v_max_f32 v120, 0, v120
    v_sub_f32 v121, 0, v120
    v_exp_f32 v121, v121
    s_nop 0
    v_mul_f32 v88, v88, v121
    v_mul_f32 v89, v89, v121
    v_mul_f32 v90, v90, v121
    v_mul_f32 v91, v91, v121
    v_mul_f32 v92, v92, v121
    v_mul_f32 v93, v93, v121
    v_mul_f32 v94, v94, v121
    v_mul_f32 v95, v95, v121
    v_mul_f32 v96, v96, v121
    v_mul_f32 v97, v97, v121
    v_mul_f32 v98, v98, v121
    v_mul_f32 v99, v99, v121
    v_mul_f32 v100, v100, v121
    v_mul_f32 v101, v101, v121
    v_mul_f32 v102, v102, v121
    v_mul_f32 v103, v103, v121
    v_sub_f32 v32, v32, v120
    v_sub_f32 v33, v33, v120
    v_sub_f32 v34, v34, v120
    v_sub_f32 v35, v35, v120
    v_sub_f32 v36, v36, v120
    v_sub_f32 v37, v37, v120
    v_sub_f32 v38, v38, v120
    v_sub_f32 v39, v39, v120
    v_sub_f32 v40, v40, v120
    v_sub_f32 v41, v41, v120
    v_sub_f32 v42, v42, v120
    v_sub_f32 v43, v43, v120
    v_sub_f32 v44, v44, v120
    v_sub_f32 v45, v45, v120
    v_sub_f32 v46, v46, v120
    v_sub_f32 v47, v47, v120
    v_sub_f32 v72, v72, v120
    v_sub_f32 v73, v73, v120
    v_sub_f32 v74, v74, v120
    v_sub_f32 v75, v75, v120
    v_sub_f32 v76, v76, v120
    v_sub_f32 v77, v77, v120
    v_sub_f32 v78, v78, v120
    v_sub_f32 v79, v79, v120
    v_sub_f32 v80, v80, v120
    v_sub_f32 v81, v81, v120
    v_sub_f32 v82, v82, v120
    v_sub_f32 v83, v83, v120
    v_sub_f32 v84, v84, v120
    v_sub_f32 v85, v85, v120
    v_sub_f32 v86, v86, v120
    v_sub_f32 v87, v87, v120
    s_branch L_back_41
    s_nop 0
L_rare_42:
    v_mov_b32 v121, v120
    s_nop 1
    v_permlane32_swap_b32 v121, v120
    v_max_f32 v120, v120, v121
    v_max_f32 v120, 0, v120
    v_sub_f32 v121, 0, v120
    v_exp_f32 v121, v121
    s_nop 0
    v_mul_f32 v88, v88, v121
    v_mul_f32 v89, v89, v121
    v_mul_f32 v90, v90, v121
    v_mul_f32 v91, v91, v121
    v_mul_f32 v92, v92, v121
    v_mul_f32 v93, v93, v121
    v_mul_f32 v94, v94, v121
    v_mul_f32 v95, v95, v121
    v_mul_f32 v96, v96, v121
    v_mul_f32 v97, v97, v121
    v_mul_f32 v98, v98, v121
    v_mul_f32 v99, v99, v121
    v_mul_f32 v100, v100, v121
    v_mul_f32 v101, v101, v121
    v_mul_f32 v102, v102, v121
    v_mul_f32 v103, v103, v121
    v_sub_f32 v32, v32, v120
    v_sub_f32 v33, v33, v120
    v_sub_f32 v34, v34, v120
    v_sub_f32 v35, v35, v120
    v_sub_f32 v36, v36, v120
    v_sub_f32 v37, v37, v120
    v_sub_f32 v38, v38, v120
    v_sub_f32 v39, v39, v120
    v_sub_f32 v40, v40, v120
    v_sub_f32 v41, v41, v120
    v_sub_f32 v42, v42, v120
    v_sub_f32 v43, v43, v120
    v_sub_f32 v44, v44, v120
    v_sub_f32 v45, v45, v120
    v_sub_f32 v46, v46, v120
    v_sub_f32 v47, v47, v120
    v_sub_f32 v72, v72, v120
    v_sub_f32 v73, v73, v120
    v_sub_f32 v74, v74, v120
    v_sub_f32 v75, v75, v120
    v_sub_f32 v76, v76, v120
    v_sub_f32 v77, v77, v120
    v_sub_f32 v78, v78, v120
    v_sub_f32 v79, v79, v120
    v_sub_f32 v80, v80, v120
    v_sub_f32 v81, v81, v120
    v_sub_f32 v82, v82, v120
    v_sub_f32 v83, v83, v120
    v_sub_f32 v84, v84, v120
    v_sub_f32 v85, v85, v120
    v_sub_f32 v86, v86, v120
    v_sub_f32 v87, v87, v120
    s_branch L_back_42
    s_nop 0
L_rare_43:
    v_mov_b32 v121, v120
    s_nop 1
    v_permlane32_swap_b32 v121, v120
    v_max_f32 v120, v120, v121
    v_max_f32 v120, 0, v120
    v_sub_f32 v121, 0, v120
    v_exp_f32 v121, v121
    s_nop 0
    v_mul_f32 v88, v88, v121
    v_mul_f32 v89, v89, v121
    v_mul_f32 v90, v90, v121
    v_mul_f32 v91, v91, v121
    v_mul_f32 v92, v92, v121
    v_mul_f32 v93, v93, v121
    v_mul_f32 v94, v94, v121
    v_mul_f32 v95, v95, v121
    v_mul_f32 v96, v96, v121
    v_mul_f32 v97, v97, v121
    v_mul_f32 v98, v98, v121
    v_mul_f32 v99, v99, v121
    v_mul_f32 v100, v100, v121
    v_mul_f32 v101, v101, v121
    v_mul_f32 v102, v102, v121
    v_mul_f32 v103, v103, v121
    v_sub_f32 v32, v32, v120
    v_sub_f32 v33, v33, v120
    v_sub_f32 v34, v34, v120
    v_sub_f32 v35, v35, v120
    v_sub_f32 v36, v36, v120
    v_sub_f32 v37, v37, v120
    v_sub_f32 v38, v38, v120
    v_sub_f32 v39, v39, v120
    v_sub_f32 v40, v40, v120
    v_sub_f32 v41, v41, v120
    v_sub_f32 v42, v42, v120
    v_sub_f32 v43, v43, v120
    v_sub_f32 v44, v44, v120
    v_sub_f32 v45, v45, v120
    v_sub_f32 v46, v46, v120
    v_sub_f32 v47, v47, v120
    v_sub_f32 v72, v72, v120
    v_sub_f32 v73, v73, v120
    v_sub_f32 v74, v74, v120
    v_sub_f32 v75, v75, v120
    v_sub_f32 v76, v76, v120
    v_sub_f32 v77, v77, v120
    v_sub_f32 v78, v78, v120
    v_sub_f32 v79, v79, v120
    v_sub_f32 v80, v80, v120
    v_sub_f32 v81, v81, v120
    v_sub_f32 v82, v82, v120
    v_sub_f32 v83, v83, v120
    v_sub_f32 v84, v84, v120
    v_sub_f32 v85, v85, v120
    v_sub_f32 v86, v86, v120
    v_sub_f32 v87, v87, v120
    s_branch L_back_43
    s_nop 0
L_rare_44:
    v_mov_b32 v121, v120
    s_nop 1
    v_permlane32_swap_b32 v121, v120
    v_max_f32 v120, v120, v121
    v_max_f32 v120, 0, v120
    v_sub_f32 v121, 0, v120
    v_exp_f32 v121, v121
    s_nop 0
    v_mul_f32 v88, v88, v121
    v_mul_f32 v89, v89, v121
    v_mul_f32 v90, v90, v121
    v_mul_f32 v91, v91, v121
    v_mul_f32 v92, v92, v121
    v_mul_f32 v93, v93, v121
    v_mul_f32 v94, v94, v121
    v_mul_f32 v95, v95, v121
    v_mul_f32 v96, v96, v121
    v_mul_f32 v97, v97, v121
    v_mul_f32 v98, v98, v121
    v_mul_f32 v99, v99, v121
    v_mul_f32 v100, v100, v121
    v_mul_f32 v101, v101, v121
    v_mul_f32 v102, v102, v121
    v_mul_f32 v103, v103, v121
    v_sub_f32 v32, v32, v120
    v_sub_f32 v33, v33, v120
    v_sub_f32 v34, v34, v120
    v_sub_f32 v35, v35, v120
    v_sub_f32 v36, v36, v120
    v_sub_f32 v37, v37, v120
    v_sub_f32 v38, v38, v120
    v_sub_f32 v39, v39, v120
    v_sub_f32 v40, v40, v120
    v_sub_f32 v41, v41, v120
    v_sub_f32 v42, v42, v120
    v_sub_f32 v43, v43, v120
    v_sub_f32 v44, v44, v120
    v_sub_f32 v45, v45, v120
    v_sub_f32 v46, v46, v120
    v_sub_f32 v47, v47, v120
    v_sub_f32 v72, v72, v120
    v_sub_f32 v73, v73, v120
    v_sub_f32 v74, v74, v120
    v_sub_f32 v75, v75, v120
    v_sub_f32 v76, v76, v120
    v_sub_f32 v77, v77, v120
    v_sub_f32 v78, v78, v120
    v_sub_f32 v79, v79, v120
    v_sub_f32 v80, v80, v120
    v_sub_f32 v81, v81, v120
    v_sub_f32 v82, v82, v120
    v_sub_f32 v83, v83, v120
    v_sub_f32 v84, v84, v120
    v_sub_f32 v85, v85, v120
    v_sub_f32 v86, v86, v120
    v_sub_f32 v87, v87, v120
    s_branch L_back_44
    s_nop 0
L_rare_45:
    v_mov_b32 v121, v120
    s_nop 1
    v_permlane32_swap_b32 v121, v120
    v_max_f32 v120, v120, v121
    v_max_f32 v120, 0, v120
    v_sub_f32 v121, 0, v120
    v_exp_f32 v121, v121
    s_nop 0
    v_mul_f32 v88, v88, v121
    v_mul_f32 v89, v89, v121
    v_mul_f32 v90, v90, v121
    v_mul_f32 v91, v91, v121
    v_mul_f32 v92, v92, v121
    v_mul_f32 v93, v93, v121
    v_mul_f32 v94, v94, v121
    v_mul_f32 v95, v95, v121
    v_mul_f32 v96, v96, v121
    v_mul_f32 v97, v97, v121
    v_mul_f32 v98, v98, v121
    v_mul_f32 v99, v99, v121
    v_mul_f32 v100, v100, v121
    v_mul_f32 v101, v101, v121
    v_mul_f32 v102, v102, v121
    v_mul_f32 v103, v103, v121
    v_sub_f32 v32, v32, v120
    v_sub_f32 v33, v33, v120
    v_sub_f32 v34, v34, v120
    v_sub_f32 v35, v35, v120
    v_sub_f32 v36, v36, v120
    v_sub_f32 v37, v37, v120
    v_sub_f32 v38, v38, v120
    v_sub_f32 v39, v39, v120
    v_sub_f32 v40, v40, v120
    v_sub_f32 v41, v41, v120
    v_sub_f32 v42, v42, v120
    v_sub_f32 v43, v43, v120
    v_sub_f32 v44, v44, v120
    v_sub_f32 v45, v45, v120
    v_sub_f32 v46, v46, v120
    v_sub_f32 v47, v47, v120
    v_sub_f32 v72, v72, v120
    v_sub_f32 v73, v73, v120
    v_sub_f32 v74, v74, v120
    v_sub_f32 v75, v75, v120
    v_sub_f32 v76, v76, v120
    v_sub_f32 v77, v77, v120
    v_sub_f32 v78, v78, v120
    v_sub_f32 v79, v79, v120
    v_sub_f32 v80, v80, v120
    v_sub_f32 v81, v81, v120
    v_sub_f32 v82, v82, v120
    v_sub_f32 v83, v83, v120
    v_sub_f32 v84, v84, v120
    v_sub_f32 v85, v85, v120
    v_sub_f32 v86, v86, v120
    v_sub_f32 v87, v87, v120
    s_branch L_back_45
    s_nop 0
L_rare_46:
    v_mov_b32 v121, v120
    s_nop 1
    v_permlane32_swap_b32 v121, v120
    v_max_f32 v120, v120, v121
    v_max_f32 v120, 0, v120
    v_sub_f32 v121, 0, v120
    v_exp_f32 v121, v121
    s_nop 0
    v_mul_f32 v88, v88, v121
    v_mul_f32 v89, v89, v121
    v_mul_f32 v90, v90, v121
    v_mul_f32 v91, v91, v121
    v_mul_f32 v92, v92, v121
    v_mul_f32 v93, v93, v121
    v_mul_f32 v94, v94, v121
    v_mul_f32 v95, v95, v121
    v_mul_f32 v96, v96, v121
    v_mul_f32 v97, v97, v121
    v_mul_f32 v98, v98, v121
    v_mul_f32 v99, v99, v121
    v_mul_f32 v100, v100, v121
    v_mul_f32 v101, v101, v121
    v_mul_f32 v102, v102, v121
    v_mul_f32 v103, v103, v121
    v_sub_f32 v32, v32, v120
    v_sub_f32 v33, v33, v120
    v_sub_f32 v34, v34, v120
    v_sub_f32 v35, v35, v120
    v_sub_f32 v36, v36, v120
    v_sub_f32 v37, v37, v120
    v_sub_f32 v38, v38, v120
    v_sub_f32 v39, v39, v120
    v_sub_f32 v40, v40, v120
    v_sub_f32 v41, v41, v120
    v_sub_f32 v42, v42, v120
    v_sub_f32 v43, v43, v120
    v_sub_f32 v44, v44, v120
    v_sub_f32 v45, v45, v120
    v_sub_f32 v46, v46, v120
    v_sub_f32 v47, v47, v120
    v_sub_f32 v72, v72, v120
    v_sub_f32 v73, v73, v120
    v_sub_f32 v74, v74, v120
    v_sub_f32 v75, v75, v120
    v_sub_f32 v76, v76, v120
    v_sub_f32 v77, v77, v120
    v_sub_f32 v78, v78, v120
    v_sub_f32 v79, v79, v120
    v_sub_f32 v80, v80, v120
    v_sub_f32 v81, v81, v120
    v_sub_f32 v82, v82, v120
    v_sub_f32 v83, v83, v120
    v_sub_f32 v84, v84, v120
    v_sub_f32 v85, v85, v120
    v_sub_f32 v86, v86, v120
    v_sub_f32 v87, v87, v120
    s_branch L_back_46
    s_nop 0
L_k2_end:
    s_endpgm
.globl oproj_kernel
.p2align 8
.type oproj_kernel,@function
oproj_kernel:
    s_cmp_ge_u32 s2, 256
    s_cbranch_scc1 L_k3_end
    s_lshr_b32 s24, s2, 7
    s_mul_i32 s25, s24, 24
    s_add_u32 s26, s0, s25
    s_addc_u32 s27, s1, 0
    s_load_dwordx2 s[4:5], s[26:27], 16
    s_load_dwordx2 s[6:7], s[0:1], 48
    s_load_dwordx2 s[8:9], s[0:1], 64
    s_and_b32 s28, s2, 127
    s_lshr_b32 s29, s28, 3
    s_and_b32 s30, s28, 7
    v_and_b32 v1, 63, v0
    v_lshrrev_b32 v2, 6, v0
    s_nop 0
    v_readfirstlane_b32 s31, v2
    s_waitcnt lgkmcnt(0)
    s_mov_b32 s12, s4
    s_and_b32 s13, s5, 0xffff
    s_mov_b32 s14, 524288
    s_mov_b32 s15, 0x00020000
    s_mov_b32 s16, s6
    s_and_b32 s17, s7, 0xffff
    s_mov_b32 s18, 4194304
    s_mov_b32 s19, 0x00020000
    s_mov_b32 s20, s8
    s_and_b32 s21, s9, 0xffff
    s_mov_b32 s22, 16777216
    s_mov_b32 s23, 0x00020000
    s_lshl_b32 s32, s29, 7
    s_lshl_b32 s33, s31, 5
    s_add_u32 s32, s32, s33
    v_and_b32 v4, 31, v1
    v_lshrrev_b32 v5, 5, v1
    v_add_u32 v3, s32, v4
    v_lshlrev_b32 v3, 5, v3
    v_lshl_add_u32 v3, v5, 4, v3
    v_lshrrev_b32 v14, 2, v0
    v_and_b32 v15, 3, v0
    v_lshlrev_b32 v15, 5, v15
    v_lshlrev_b32 v8, 10, v14
    s_lshl_b32 s34, s30, 7
    v_add3_u32 v8, v8, v15, s34
    s_movk_i32 s35, 192
    v_mul_lo_u32 v7, v14, s35
    v_add_u32 v7, v7, v15
    v_lshrrev_b32 v16, 2, v1
    v_and_b32 v16, 3, v16
    v_lshl_add_u32 v16, v5, 3, v16
    v_mul_lo_u32 v20, v16, s35
    v_lshrrev_b32 v17, 4, v1
    v_and_b32 v17, 1, v17
    v_lshlrev_b32 v17, 5, v17
    v_and_b32 v18, 3, v1
    v_lshl_add_u32 v17, v18, 3, v17
    v_add_u32 v20, v20, v17
    v_mov_b32 v64, 0
    v_mov_b32 v65, 0
    v_mov_b32 v66, 0
    v_mov_b32 v67, 0
    v_mov_b32 v68, 0
    v_mov_b32 v69, 0
    v_mov_b32 v70, 0
    v_mov_b32 v71, 0
    v_mov_b32 v72, 0
    v_mov_b32 v73, 0
    v_mov_b32 v74, 0
    v_mov_b32 v75, 0
    v_mov_b32 v76, 0
    v_mov_b32 v77, 0
    v_mov_b32 v78, 0
    v_mov_b32 v79, 0
    v_mov_b32 v80, 0
    v_mov_b32 v81, 0
    v_mov_b32 v82, 0
    v_mov_b32 v83, 0
    v_mov_b32 v84, 0
    v_mov_b32 v85, 0
    v_mov_b32 v86, 0
    v_mov_b32 v87, 0
    v_mov_b32 v88, 0
    v_mov_b32 v89, 0
    v_mov_b32 v90, 0
    v_mov_b32 v91, 0
    v_mov_b32 v92, 0
    v_mov_b32 v93, 0
    v_mov_b32 v94, 0
    v_mov_b32 v95, 0
    s_lshl_b32 s36, s24, 21
    s_add_u32 s36, s36, 12582912
    s_mov_b32 s37, 0
    buffer_load_dwordx4 v[40:43], v8, s[12:15], s37 offen offset:0
    buffer_load_dwordx4 v[44:47], v8, s[12:15], s37 offen offset:16
    s_add_u32 s38, s36, 0
    buffer_load_dwordx4 v[96:99], v3, s[20:23], s38 offen
    s_add_u32 s38, s36, 65536
    buffer_load_dwordx4 v[100:103], v3, s[20:23], s38 offen
    s_add_u32 s38, s36, 131072
    buffer_load_dwordx4 v[104:107], v3, s[20:23], s38 offen
    s_add_u32 s38, s36, 196608
    buffer_load_dwordx4 v[108:111], v3, s[20:23], s38 offen
    s_mov_b32 s37, 65536
    buffer_load_dwordx4 v[48:51], v8, s[12:15], s37 offen offset:0
    buffer_load_dwordx4 v[52:55], v8, s[12:15], s37 offen offset:16
    s_add_u32 s38, s36, 262144
    buffer_load_dwordx4 v[112:115], v3, s[20:23], s38 offen
    s_add_u32 s38, s36, 327680
    buffer_load_dwordx4 v[116:119], v3, s[20:23], s38 offen
    s_add_u32 s38, s36, 393216
    buffer_load_dwordx4 v[120:123], v3, s[20:23], s38 offen
    s_add_u32 s38, s36, 458752
    buffer_load_dwordx4 v[124:127], v3, s[20:23], s38 offen
    s_waitcnt vmcnt(6)
    ds_write_b128 v7, v[40:43] offset:0
    ds_write_b128 v7, v[44:47] offset:16
    s_waitcnt lgkmcnt(0)
    s_barrier
    s_mov_b32 s37, 131072
    buffer_load_dwordx4 v[40:43], v8, s[12:15], s37 offen offset:0
    buffer_load_dwordx4 v[44:47], v8, s[12:15], s37 offen offset:16
    s_add_u32 s38, s36, 524288
    buffer_load_dwordx4 v[128:131], v3, s[20:23], s38 offen
    s_add_u32 s38, s36, 589824
    buffer_load_dwordx4 v[132:135], v3, s[20:23], s38 offen
    s_add_u32 s38, s36, 655360
    buffer_load_dwordx4 v[136:139], v3, s[20:23], s38 offen
    s_add_u32 s38, s36, 720896
    buffer_load_dwordx4 v[140:143], v3, s[20:23], s38 offen
    ds_read_b64_tr_b16 v[24:25], v20 offset:0
    ds_read_b64_tr_b16 v[26:27], v20 offset:768
    ds_read_b64_tr_b16 v[28:29], v20 offset:64
    ds_read_b64_tr_b16 v[30:31], v20 offset:832
    ds_read_b64_tr_b16 v[32:33], v20 offset:3072
    ds_read_b64_tr_b16 v[34:35], v20 offset:3840
    ds_read_b64_tr_b16 v[36:37], v20 offset:3136
    ds_read_b64_tr_b16 v[38:39], v20 offset:3904
    s_waitcnt lgkmcnt(4)
    v_mfma_f32_32x32x16_bf16 v[64:79], v[24:27], v[96:99], v[64:79]
    v_mfma_f32_32x32x16_bf16 v[80:95], v[28:31], v[96:99], v[80:95]
    ds_read_b64_tr_b16 v[24:25], v20 offset:6144
    ds_read_b64_tr_b16 v[26:27], v20 offset:6912
    ds_read_b64_tr_b16 v[28:29], v20 offset:6208
    ds_read_b64_tr_b16 v[30:31], v20 offset:6976
    s_waitcnt lgkmcnt(4)
    v_mfma_f32_32x32x16_bf16 v[64:79], v[32:35], v[100:103], v[64:79]
    v_mfma_f32_32x32x16_bf16 v[80:95], v[36:39], v[100:103], v[80:95]
    ds_read_b64_tr_b16 v[32:33], v20 offset:9216
    ds_read_b64_tr_b16 v[34:35], v20 offset:9984
    ds_read_b64_tr_b16 v[36:37], v20 offset:9280
    ds_read_b64_tr_b16 v[38:39], v20 offset:10048
    s_waitcnt lgkmcnt(4)
    v_mfma_f32_32x32x16_bf16 v[64:79], v[24:27], v[104:107], v[64:79]
    v_mfma_f32_32x32x16_bf16 v[80:95], v[28:31], v[104:107], v[80:95]
    s_waitcnt lgkmcnt(0)
    v_mfma_f32_32x32x16_bf16 v[64:79], v[32:35], v[108:111], v[64:79]
    v_mfma_f32_32x32x16_bf16 v[80:95], v[36:39], v[108:111], v[80:95]
    s_waitcnt vmcnt(6)
    ds_write_b128 v7, v[48:51] offset:12288
    ds_write_b128 v7, v[52:55] offset:12304
    s_waitcnt lgkmcnt(0)
    s_barrier
    s_mov_b32 s37, 196608
    buffer_load_dwordx4 v[48:51], v8, s[12:15], s37 offen offset:0
    buffer_load_dwordx4 v[52:55], v8, s[12:15], s37 offen offset:16
    s_add_u32 s38, s36, 786432
    buffer_load_dwordx4 v[96:99], v3, s[20:23], s38 offen
    s_add_u32 s38, s36, 851968
    buffer_load_dwordx4 v[100:103], v3, s[20:23], s38 offen
    s_add_u32 s38, s36, 917504
    buffer_load_dwordx4 v[104:107], v3, s[20:23], s38 offen
    s_add_u32 s38, s36, 983040
    buffer_load_dwordx4 v[108:111], v3, s[20:23], s38 offen
    ds_read_b64_tr_b16 v[24:25], v20 offset:12288
    ds_read_b64_tr_b16 v[26:27], v20 offset:13056
    ds_read_b64_tr_b16 v[28:29], v20 offset:12352
    ds_read_b64_tr_b16 v[30:31], v20 offset:13120
    ds_read_b64_tr_b16 v[32:33], v20 offset:15360
    ds_read_b64_tr_b16 v[34:35], v20 offset:16128
    ds_read_b64_tr_b16 v[36:37], v20 offset:15424
    ds_read_b64_tr_b16 v[38:39], v20 offset:16192
    s_waitcnt lgkmcnt(4)
    v_mfma_f32_32x32x16_bf16 v[64:79], v[24:27], v[112:115], v[64:79]
    v_mfma_f32_32x32x16_bf16 v[80:95], v[28:31], v[112:115], v[80:95]
    ds_read_b64_tr_b16 v[24:25], v20 offset:18432
    ds_read_b64_tr_b16 v[26:27], v20 offset:19200
    ds_read_b64_tr_b16 v[28:29], v20 offset:18496
    ds_read_b64_tr_b16 v[30:31], v20 offset:19264
    s_waitcnt lgkmcnt(4)
    v_mfma_f32_32x32x16_bf16 v[64:79], v[32:35], v[116:119], v[64:79]
    v_mfma_f32_32x32x16_bf16 v[80:95], v[36:39], v[116:119], v[80:95]
    ds_read_b64_tr_b16 v[32:33], v20 offset:21504
    ds_read_b64_tr_b16 v[34:35], v20 offset:22272
    ds_read_b64_tr_b16 v[36:37], v20 offset:21568
    ds_read_b64_tr_b16 v[38:39], v20 offset:22336
    s_waitcnt lgkmcnt(4)
    v_mfma_f32_32x32x16_bf16 v[64:79], v[24:27], v[120:123], v[64:79]
    v_mfma_f32_32x32x16_bf16 v[80:95], v[28:31], v[120:123], v[80:95]
    s_waitcnt lgkmcnt(0)
    v_mfma_f32_32x32x16_bf16 v[64:79], v[32:35], v[124:127], v[64:79]
    v_mfma_f32_32x32x16_bf16 v[80:95], v[36:39], v[124:127], v[80:95]
    s_waitcnt vmcnt(6)
    ds_write_b128 v7, v[40:43] offset:24576
    ds_write_b128 v7, v[44:47] offset:24592
    s_waitcnt lgkmcnt(0)
    s_barrier
    s_mov_b32 s37, 262144
    buffer_load_dwordx4 v[40:43], v8, s[12:15], s37 offen offset:0
    buffer_load_dwordx4 v[44:47], v8, s[12:15], s37 offen offset:16
    s_add_u32 s38, s36, 1048576
    buffer_load_dwordx4 v[112:115], v3, s[20:23], s38 offen
    s_add_u32 s38, s36, 1114112
    buffer_load_dwordx4 v[116:119], v3, s[20:23], s38 offen
    s_add_u32 s38, s36, 1179648
    buffer_load_dwordx4 v[120:123], v3, s[20:23], s38 offen
    s_add_u32 s38, s36, 1245184
    buffer_load_dwordx4 v[124:127], v3, s[20:23], s38 offen
    ds_read_b64_tr_b16 v[24:25], v20 offset:24576
    ds_read_b64_tr_b16 v[26:27], v20 offset:25344
    ds_read_b64_tr_b16 v[28:29], v20 offset:24640
    ds_read_b64_tr_b16 v[30:31], v20 offset:25408
    ds_read_b64_tr_b16 v[32:33], v20 offset:27648
    ds_read_b64_tr_b16 v[34:35], v20 offset:28416
    ds_read_b64_tr_b16 v[36:37], v20 offset:27712
    ds_read_b64_tr_b16 v[38:39], v20 offset:28480
    s_waitcnt lgkmcnt(4)
    v_mfma_f32_32x32x16_bf16 v[64:79], v[24:27], v[128:131], v[64:79]
    v_mfma_f32_32x32x16_bf16 v[80:95], v[28:31], v[128:131], v[80:95]
    ds_read_b64_tr_b16 v[24:25], v20 offset:30720
    ds_read_b64_tr_b16 v[26:27], v20 offset:31488
    ds_read_b64_tr_b16 v[28:29], v20 offset:30784
    ds_read_b64_tr_b16 v[30:31], v20 offset:31552
    s_waitcnt lgkmcnt(4)
    v_mfma_f32_32x32x16_bf16 v[64:79], v[32:35], v[132:135], v[64:79]
    v_mfma_f32_32x32x16_bf16 v[80:95], v[36:39], v[132:135], v[80:95]
    ds_read_b64_tr_b16 v[32:33], v20 offset:33792
    ds_read_b64_tr_b16 v[34:35], v20 offset:34560
    ds_read_b64_tr_b16 v[36:37], v20 offset:33856
    ds_read_b64_tr_b16 v[38:39], v20 offset:34624
    s_waitcnt lgkmcnt(4)
    v_mfma_f32_32x32x16_bf16 v[64:79], v[24:27], v[136:139], v[64:79]
    v_mfma_f32_32x32x16_bf16 v[80:95], v[28:31], v[136:139], v[80:95]
    s_waitcnt lgkmcnt(0)
    v_mfma_f32_32x32x16_bf16 v[64:79], v[32:35], v[140:143], v[64:79]
    v_mfma_f32_32x32x16_bf16 v[80:95], v[36:39], v[140:143], v[80:95]
    s_waitcnt vmcnt(6)
    ds_write_b128 v7, v[48:51] offset:0
    ds_write_b128 v7, v[52:55] offset:16
    s_waitcnt lgkmcnt(0)
    s_barrier
    s_mov_b32 s37, 327680
    buffer_load_dwordx4 v[48:51], v8, s[12:15], s37 offen offset:0
    buffer_load_dwordx4 v[52:55], v8, s[12:15], s37 offen offset:16
    s_add_u32 s38, s36, 1310720
    buffer_load_dwordx4 v[128:131], v3, s[20:23], s38 offen
    s_add_u32 s38, s36, 1376256
    buffer_load_dwordx4 v[132:135], v3, s[20:23], s38 offen
    s_add_u32 s38, s36, 1441792
    buffer_load_dwordx4 v[136:139], v3, s[20:23], s38 offen
    s_add_u32 s38, s36, 1507328
    buffer_load_dwordx4 v[140:143], v3, s[20:23], s38 offen
    ds_read_b64_tr_b16 v[24:25], v20 offset:0
    ds_read_b64_tr_b16 v[26:27], v20 offset:768
    ds_read_b64_tr_b16 v[28:29], v20 offset:64
    ds_read_b64_tr_b16 v[30:31], v20 offset:832
    ds_read_b64_tr_b16 v[32:33], v20 offset:3072
    ds_read_b64_tr_b16 v[34:35], v20 offset:3840
    ds_read_b64_tr_b16 v[36:37], v20 offset:3136
    ds_read_b64_tr_b16 v[38:39], v20 offset:3904
    s_waitcnt lgkmcnt(4)
    v_mfma_f32_32x32x16_bf16 v[64:79], v[24:27], v[96:99], v[64:79]
    v_mfma_f32_32x32x16_bf16 v[80:95], v[28:31], v[96:99], v[80:95]
    ds_read_b64_tr_b16 v[24:25], v20 offset:6144
    ds_read_b64_tr_b16 v[26:27], v20 offset:6912
    ds_read_b64_tr_b16 v[28:29], v20 offset:6208
    ds_read_b64_tr_b16 v[30:31], v20 offset:6976
    s_waitcnt lgkmcnt(4)
    v_mfma_f32_32x32x16_bf16 v[64:79], v[32:35], v[100:103], v[64:79]
    v_mfma_f32_32x32x16_bf16 v[80:95], v[36:39], v[100:103], v[80:95]
    ds_read_b64_tr_b16 v[32:33], v20 offset:9216
    ds_read_b64_tr_b16 v[34:35], v20 offset:9984
    ds_read_b64_tr_b16 v[36:37], v20 offset:9280
    ds_read_b64_tr_b16 v[38:39], v20 offset:10048
    s_waitcnt lgkmcnt(4)
    v_mfma_f32_32x32x16_bf16 v[64:79], v[24:27], v[104:107], v[64:79]
    v_mfma_f32_32x32x16_bf16 v[80:95], v[28:31], v[104:107], v[80:95]
    s_waitcnt lgkmcnt(0)
    v_mfma_f32_32x32x16_bf16 v[64:79], v[32:35], v[108:111], v[64:79]
    v_mfma_f32_32x32x16_bf16 v[80:95], v[36:39], v[108:111], v[80:95]
    s_waitcnt vmcnt(6)
    ds_write_b128 v7, v[40:43] offset:12288
    ds_write_b128 v7, v[44:47] offset:12304
    s_waitcnt lgkmcnt(0)
    s_barrier
    s_mov_b32 s37, 393216
    buffer_load_dwordx4 v[40:43], v8, s[12:15], s37 offen offset:0
    buffer_load_dwordx4 v[44:47], v8, s[12:15], s37 offen offset:16
    s_add_u32 s38, s36, 1572864
    buffer_load_dwordx4 v[96:99], v3, s[20:23], s38 offen
    s_add_u32 s38, s36, 1638400
    buffer_load_dwordx4 v[100:103], v3, s[20:23], s38 offen
    s_add_u32 s38, s36, 1703936
    buffer_load_dwordx4 v[104:107], v3, s[20:23], s38 offen
    s_add_u32 s38, s36, 1769472
    buffer_load_dwordx4 v[108:111], v3, s[20:23], s38 offen
    ds_read_b64_tr_b16 v[24:25], v20 offset:12288
    ds_read_b64_tr_b16 v[26:27], v20 offset:13056
    ds_read_b64_tr_b16 v[28:29], v20 offset:12352
    ds_read_b64_tr_b16 v[30:31], v20 offset:13120
    ds_read_b64_tr_b16 v[32:33], v20 offset:15360
    ds_read_b64_tr_b16 v[34:35], v20 offset:16128
    ds_read_b64_tr_b16 v[36:37], v20 offset:15424
    ds_read_b64_tr_b16 v[38:39], v20 offset:16192
    s_waitcnt lgkmcnt(4)
    v_mfma_f32_32x32x16_bf16 v[64:79], v[24:27], v[112:115], v[64:79]
    v_mfma_f32_32x32x16_bf16 v[80:95], v[28:31], v[112:115], v[80:95]
    ds_read_b64_tr_b16 v[24:25], v20 offset:18432
    ds_read_b64_tr_b16 v[26:27], v20 offset:19200
    ds_read_b64_tr_b16 v[28:29], v20 offset:18496
    ds_read_b64_tr_b16 v[30:31], v20 offset:19264
    s_waitcnt lgkmcnt(4)
    v_mfma_f32_32x32x16_bf16 v[64:79], v[32:35], v[116:119], v[64:79]
    v_mfma_f32_32x32x16_bf16 v[80:95], v[36:39], v[116:119], v[80:95]
    ds_read_b64_tr_b16 v[32:33], v20 offset:21504
    ds_read_b64_tr_b16 v[34:35], v20 offset:22272
    ds_read_b64_tr_b16 v[36:37], v20 offset:21568
    ds_read_b64_tr_b16 v[38:39], v20 offset:22336
    s_waitcnt lgkmcnt(4)
    v_mfma_f32_32x32x16_bf16 v[64:79], v[24:27], v[120:123], v[64:79]
    v_mfma_f32_32x32x16_bf16 v[80:95], v[28:31], v[120:123], v[80:95]
    s_waitcnt lgkmcnt(0)
    v_mfma_f32_32x32x16_bf16 v[64:79], v[32:35], v[124:127], v[64:79]
    v_mfma_f32_32x32x16_bf16 v[80:95], v[36:39], v[124:127], v[80:95]
    s_waitcnt vmcnt(6)
    ds_write_b128 v7, v[48:51] offset:24576
    ds_write_b128 v7, v[52:55] offset:24592
    s_waitcnt lgkmcnt(0)
    s_barrier
    s_mov_b32 s37, 458752
    buffer_load_dwordx4 v[48:51], v8, s[12:15], s37 offen offset:0
    buffer_load_dwordx4 v[52:55], v8, s[12:15], s37 offen offset:16
    s_add_u32 s38, s36, 1835008
    buffer_load_dwordx4 v[112:115], v3, s[20:23], s38 offen
    s_add_u32 s38, s36, 1900544
    buffer_load_dwordx4 v[116:119], v3, s[20:23], s38 offen
    s_add_u32 s38, s36, 1966080
    buffer_load_dwordx4 v[120:123], v3, s[20:23], s38 offen
    s_add_u32 s38, s36, 2031616
    buffer_load_dwordx4 v[124:127], v3, s[20:23], s38 offen
    ds_read_b64_tr_b16 v[24:25], v20 offset:24576
    ds_read_b64_tr_b16 v[26:27], v20 offset:25344
    ds_read_b64_tr_b16 v[28:29], v20 offset:24640
    ds_read_b64_tr_b16 v[30:31], v20 offset:25408
    ds_read_b64_tr_b16 v[32:33], v20 offset:27648
    ds_read_b64_tr_b16 v[34:35], v20 offset:28416
    ds_read_b64_tr_b16 v[36:37], v20 offset:27712
    ds_read_b64_tr_b16 v[38:39], v20 offset:28480
    s_waitcnt lgkmcnt(4)
    v_mfma_f32_32x32x16_bf16 v[64:79], v[24:27], v[128:131], v[64:79]
    v_mfma_f32_32x32x16_bf16 v[80:95], v[28:31], v[128:131], v[80:95]
    ds_read_b64_tr_b16 v[24:25], v20 offset:30720
    ds_read_b64_tr_b16 v[26:27], v20 offset:31488
    ds_read_b64_tr_b16 v[28:29], v20 offset:30784
    ds_read_b64_tr_b16 v[30:31], v20 offset:31552
    s_waitcnt lgkmcnt(4)
    v_mfma_f32_32x32x16_bf16 v[64:79], v[32:35], v[132:135], v[64:79]
    v_mfma_f32_32x32x16_bf16 v[80:95], v[36:39], v[132:135], v[80:95]
    ds_read_b64_tr_b16 v[32:33], v20 offset:33792
    ds_read_b64_tr_b16 v[34:35], v20 offset:34560
    ds_read_b64_tr_b16 v[36:37], v20 offset:33856
    ds_read_b64_tr_b16 v[38:39], v20 offset:34624
    s_waitcnt lgkmcnt(4)
    v_mfma_f32_32x32x16_bf16 v[64:79], v[24:27], v[136:139], v[64:79]
    v_mfma_f32_32x32x16_bf16 v[80:95], v[28:31], v[136:139], v[80:95]
    s_waitcnt lgkmcnt(0)
    v_mfma_f32_32x32x16_bf16 v[64:79], v[32:35], v[140:143], v[64:79]
    v_mfma_f32_32x32x16_bf16 v[80:95], v[36:39], v[140:143], v[80:95]
    s_waitcnt vmcnt(6)
    ds_write_b128 v7, v[40:43] offset:0
    ds_write_b128 v7, v[44:47] offset:16
    s_waitcnt lgkmcnt(0)
    s_barrier
    ds_read_b64_tr_b16 v[24:25], v20 offset:0
    ds_read_b64_tr_b16 v[26:27], v20 offset:768
    ds_read_b64_tr_b16 v[28:29], v20 offset:64
    ds_read_b64_tr_b16 v[30:31], v20 offset:832
    ds_read_b64_tr_b16 v[32:33], v20 offset:3072
    ds_read_b64_tr_b16 v[34:35], v20 offset:3840
    ds_read_b64_tr_b16 v[36:37], v20 offset:3136
    ds_read_b64_tr_b16 v[38:39], v20 offset:3904
    s_waitcnt lgkmcnt(4)
    v_mfma_f32_32x32x16_bf16 v[64:79], v[24:27], v[96:99], v[64:79]
    v_mfma_f32_32x32x16_bf16 v[80:95], v[28:31], v[96:99], v[80:95]
    ds_read_b64_tr_b16 v[24:25], v20 offset:6144
    ds_read_b64_tr_b16 v[26:27], v20 offset:6912
    ds_read_b64_tr_b16 v[28:29], v20 offset:6208
    ds_read_b64_tr_b16 v[30:31], v20 offset:6976
    s_waitcnt lgkmcnt(4)
    v_mfma_f32_32x32x16_bf16 v[64:79], v[32:35], v[100:103], v[64:79]
    v_mfma_f32_32x32x16_bf16 v[80:95], v[36:39], v[100:103], v[80:95]
    ds_read_b64_tr_b16 v[32:33], v20 offset:9216
    ds_read_b64_tr_b16 v[34:35], v20 offset:9984
    ds_read_b64_tr_b16 v[36:37], v20 offset:9280
    ds_read_b64_tr_b16 v[38:39], v20 offset:10048
    s_waitcnt lgkmcnt(4)
    v_mfma_f32_32x32x16_bf16 v[64:79], v[24:27], v[104:107], v[64:79]
    v_mfma_f32_32x32x16_bf16 v[80:95], v[28:31], v[104:107], v[80:95]
    s_waitcnt lgkmcnt(0)
    v_mfma_f32_32x32x16_bf16 v[64:79], v[32:35], v[108:111], v[64:79]
    v_mfma_f32_32x32x16_bf16 v[80:95], v[36:39], v[108:111], v[80:95]
    s_waitcnt vmcnt(0)
    ds_write_b128 v7, v[48:51] offset:12288
    ds_write_b128 v7, v[52:55] offset:12304
    s_waitcnt lgkmcnt(0)
    s_barrier
    ds_read_b64_tr_b16 v[24:25], v20 offset:12288
    ds_read_b64_tr_b16 v[26:27], v20 offset:13056
    ds_read_b64_tr_b16 v[28:29], v20 offset:12352
    ds_read_b64_tr_b16 v[30:31], v20 offset:13120
    ds_read_b64_tr_b16 v[32:33], v20 offset:15360
    ds_read_b64_tr_b16 v[34:35], v20 offset:16128
    ds_read_b64_tr_b16 v[36:37], v20 offset:15424
    ds_read_b64_tr_b16 v[38:39], v20 offset:16192
    s_waitcnt lgkmcnt(4)
    v_mfma_f32_32x32x16_bf16 v[64:79], v[24:27], v[112:115], v[64:79]
    v_mfma_f32_32x32x16_bf16 v[80:95], v[28:31], v[112:115], v[80:95]
    ds_read_b64_tr_b16 v[24:25], v20 offset:18432
    ds_read_b64_tr_b16 v[26:27], v20 offset:19200
    ds_read_b64_tr_b16 v[28:29], v20 offset:18496
    ds_read_b64_tr_b16 v[30:31], v20 offset:19264
    s_waitcnt lgkmcnt(4)
    v_mfma_f32_32x32x16_bf16 v[64:79], v[32:35], v[116:119], v[64:79]
    v_mfma_f32_32x32x16_bf16 v[80:95], v[36:39], v[116:119], v[80:95]
    ds_read_b64_tr_b16 v[32:33], v20 offset:21504
    ds_read_b64_tr_b16 v[34:35], v20 offset:22272
    ds_read_b64_tr_b16 v[36:37], v20 offset:21568
    ds_read_b64_tr_b16 v[38:39], v20 offset:22336
    s_waitcnt lgkmcnt(4)
    v_mfma_f32_32x32x16_bf16 v[64:79], v[24:27], v[120:123], v[64:79]
    v_mfma_f32_32x32x16_bf16 v[80:95], v[28:31], v[120:123], v[80:95]
    s_waitcnt lgkmcnt(0)
    v_mfma_f32_32x32x16_bf16 v[64:79], v[32:35], v[124:127], v[64:79]
    v_mfma_f32_32x32x16_bf16 v[80:95], v[36:39], v[124:127], v[80:95]
    v_add_u32 v21, s32, v4
    v_lshlrev_b32 v21, 11, v21
    v_lshl_add_u32 v21, v5, 3, v21
    s_lshl_b32 s39, s24, 10
    s_lshl_b32 s40, s30, 7
    s_add_u32 s39, s39, s40
    s_nop 4
    v_cvt_pk_bf16_f32 v24, v64, v65
    v_cvt_pk_bf16_f32 v25, v66, v67
    v_cvt_pk_bf16_f32 v26, v68, v69
    v_cvt_pk_bf16_f32 v27, v70, v71
    v_cvt_pk_bf16_f32 v28, v72, v73
    v_cvt_pk_bf16_f32 v29, v74, v75
    v_cvt_pk_bf16_f32 v30, v76, v77
    v_cvt_pk_bf16_f32 v31, v78, v79
    buffer_store_dwordx2 v[24:25], v21, s[16:19], s39 offen offset:0
    buffer_store_dwordx2 v[26:27], v21, s[16:19], s39 offen offset:16
    buffer_store_dwordx2 v[28:29], v21, s[16:19], s39 offen offset:32
    buffer_store_dwordx2 v[30:31], v21, s[16:19], s39 offen offset:48
    v_cvt_pk_bf16_f32 v24, v80, v81
    v_cvt_pk_bf16_f32 v25, v82, v83
    v_cvt_pk_bf16_f32 v26, v84, v85
    v_cvt_pk_bf16_f32 v27, v86, v87
    v_cvt_pk_bf16_f32 v28, v88, v89
    v_cvt_pk_bf16_f32 v29, v90, v91
    v_cvt_pk_bf16_f32 v30, v92, v93
    v_cvt_pk_bf16_f32 v31, v94, v95
    buffer_store_dwordx2 v[24:25], v21, s[16:19], s39 offen offset:64
    buffer_store_dwordx2 v[26:27], v21, s[16:19], s39 offen offset:80
    buffer_store_dwordx2 v[28:29], v21, s[16:19], s39 offen offset:96
    buffer_store_dwordx2 v[30:31], v21, s[16:19], s39 offen offset:112
    s_waitcnt vmcnt(0)
L_k3_end:
    s_endpgm

.section .rodata,"a"
.p2align 6
.amdhsa_kernel qkv_kernel
  .amdhsa_next_free_vgpr 344
  .amdhsa_next_free_sgpr 96
  .amdhsa_accum_offset 248
  .amdhsa_group_segment_fixed_size 0
  .amdhsa_kernarg_size 72
  .amdhsa_user_sgpr_count 2
  .amdhsa_user_sgpr_kernarg_segment_ptr 1
  .amdhsa_system_sgpr_workgroup_id_x 1
.end_amdhsa_kernel
.text

.section .rodata,"a"
.p2align 6
.amdhsa_kernel attn_kernel
  .amdhsa_next_free_vgpr 128
  .amdhsa_next_free_sgpr 96
  .amdhsa_accum_offset 128
  .amdhsa_group_segment_fixed_size 0
  .amdhsa_kernarg_size 72
  .amdhsa_user_sgpr_count 2
  .amdhsa_user_sgpr_kernarg_segment_ptr 1
  .amdhsa_system_sgpr_workgroup_id_x 1
.end_amdhsa_kernel
.text

.section .rodata,"a"
.p2align 6
.amdhsa_kernel oproj_kernel
  .amdhsa_next_free_vgpr 144
  .amdhsa_next_free_sgpr 96
  .amdhsa_accum_offset 144
  .amdhsa_group_segment_fixed_size 0
  .amdhsa_kernarg_size 72
  .amdhsa_user_sgpr_count 2
  .amdhsa_user_sgpr_kernarg_segment_ptr 1
  .amdhsa_system_sgpr_workgroup_id_x 1
.end_amdhsa_kernel
.text
```
